```python
import torch

def _softmax(x, axis=-1):
    return torch.softmax(x, dim=axis)
def _gelu(x):
    return torch.nn.functional.gelu(x, approximate="tanh")
def _silu(x):
    return torch.nn.functional.silu(x)
def _sigmoid(x):
    return torch.sigmoid(x)
def _layernorm(x, axis=-1, eps=1e-5):
    m = x.mean(dim=axis, keepdim=True)
    v = x.var(dim=axis, keepdim=True, unbiased=False)
    return (x - m) / torch.sqrt(v + eps)
def _scatter_add(tgt, idx, src, axis=0):
    return tgt.clone().index_add_(axis, idx, src)
def _segment_sum(src, seg, n):
    out = torch.zeros((n,) + src.shape[1:], dtype=src.dtype)
    return out.index_add_(0, seg, src)
def _pad(x, pw):
    flat = tuple(v for pair in reversed(pw) for v in pair)
    return torch.nn.functional.pad(x, flat)

kernel_name = 'standalone__gqa_block_cached__near_ridge'

def setup_inputs():

    _w = (lambda a: (lambda t: t.to(torch.bfloat16) if t.is_floating_point() else t)(torch.as_tensor(a)))
    B, Sq, D = 8, 48, 1024
    Hq, Hkv, Sk, Dh = 32, 4, 2048, 128
    assert Hq % Hkv == 0, (Hq, Hkv)
    return {
        "x": _w((lambda *s: torch.randn(*s, dtype=torch.bfloat16) * 0.8)(B, Sq, D)),
        "k_cache": _w((lambda *s: torch.randn(*s, dtype=torch.bfloat16) * 0.8)(B, Hkv, Sk, Dh)),
        "v_cache": _w((lambda *s: torch.randn(*s, dtype=torch.bfloat16) * 0.05)(B, Hkv, Sk, Dh)),
        "wq": _w((lambda *s: torch.randn(*s, dtype=torch.bfloat16) * 0.8)(D, Hq * Dh) * (D ** -0.5)),
        "wo": _w((lambda *s: torch.randn(*s, dtype=torch.bfloat16) * 0.05)(Hq * Dh, D) * ((Hq * Dh) ** -0.5)),
    }

def reference(x, k_cache, v_cache, wq, wo):
    B, Sq, D = x.shape
    Hq, Dh = 32, 128
    Hkv = k_cache.shape[1]
    rep = Hq // Hkv
    q = (lambda x, *d: x.permute(*d))((x @ wq).reshape(B, Sq, Hq, Dh), 0, 2, 1, 3)
    k = (lambda x, n, axis: torch.repeat_interleave(x, n, dim=axis))(k_cache, rep, axis=1)
    v = (lambda x, n, axis: torch.repeat_interleave(x, n, dim=axis))(v_cache, rep, axis=1)
    scores = torch.einsum("bhqd,bhkd->bhqk", q, k) * (Dh ** -0.5)
    p = _softmax(scores, axis=-1)
    o = torch.einsum("bhqk,bhkd->bhqd", p, v)
    return (lambda x, *d: x.permute(*d))(o, 0, 2, 1, 3).reshape(B, Sq, Hq * Dh) @ wo
```

```asm
; @launch kernel=gqa_attn_kernel grid=(256,1,1) block=(512,1,1) lds=163840
; @launch kernel=gqa_oproj_kernel grid=(256,1,1) block=(512,1,1) lds=49152
.amdgcn_target "amdgcn-amd-amdhsa--gfx950"
.text
.globl gqa_attn_kernel
.p2align 8
.type gqa_attn_kernel,@function
gqa_attn_kernel:
    s_cmp_ge_u32 s2, 256
    s_cbranch_scc1 L_end0
    s_load_dwordx8 s[4:11], s[0:1], 0
    s_load_dwordx2 s[12:13], s[0:1], 32
    s_load_dwordx2 s[14:15], s[0:1], 56
    v_lshrrev_b32 v1, 6, v0
    v_and_b32 v0, 63, v0
    v_readfirstlane_b32 s3, v1
    s_and_b32 s16, s2, 7
    s_lshr_b32 s17, s2, 3
    s_lshr_b32 s18, s16, 2
    s_lshl_b32 s18, s18, 2
    s_lshr_b32 s19, s17, 3
    s_add_u32 s18, s18, s19
    s_and_b32 s19, s16, 3
    s_lshl_b32 s20, s19, 3
    s_and_b32 s21, s17, 7
    s_add_u32 s20, s20, s21
    s_mul_i32 s22, s18, 98304
    s_lshl_b32 s23, s20, 8
    s_lshl_b32 s24, s3, 16
    s_add_u32 s23, s23, s24
    s_lshl_b32 s25, s18, 2
    s_add_u32 s25, s25, s19
    s_lshl_b32 s25, s25, 19
    s_add_u32 s25, s25, s24
    s_lshl_b32 s28, s3, 12
    s_and_b32 s37, s3, 3
    s_lshl_b32 s26, s37, 10
    s_lshl_b32 s27, s37, 12
    s_lshl_b32 s23, s20, 8
    s_lshl_b32 s24, s37, 17
    s_add_u32 s23, s23, s24
    v_lshrrev_b32 v24, 5, v0
    s_lshl_b32 s29, s37, 1
    v_add_u32 v24, s29, v24
    v_lshlrev_b32 v25, 1, v24
    v_and_b32 v26, 31, v0
    v_xor_b32 v25, v25, v26
    v_lshlrev_b32 v25, 4, v25
    v_lshl_add_u32 v84, v24, 11, v25
    v_lshrrev_b32 v24, 4, v0
    v_and_b32 v26, 15, v0
    v_lshlrev_b32 v25, 1, v24
    v_xor_b32 v25, v25, v26
    v_lshlrev_b32 v25, 4, v25
    v_lshl_add_u32 v80, v24, 13, v25
    v_add_u32 v81, 31744, v80
    v_xor_b32 v82, 128, v80
    v_add_u32 v82, 63488, v82
    v_add_u32 v83, 31744, v82
    v_lshl_add_u32 v2, v24, 8, v25
    v_xor_b32 v3, 128, v2
    s_waitcnt lgkmcnt(0)
    s_mov_b32 s44, s4
    s_mov_b32 s45, s5
    s_mov_b32 s46, 786432
    s_mov_b32 s47, 0x00020000
    s_mov_b32 s56, s10
    s_mov_b32 s57, s11
    s_mov_b32 s58, 8388608
    s_mov_b32 s59, 0x00020000
    s_mov_b32 s48, s6
    s_mov_b32 s49, s7
    s_mov_b32 s50, 16777216
    s_mov_b32 s51, 0x00020000
    s_mov_b32 s52, s8
    s_mov_b32 s53, s9
    s_mov_b32 s54, 16777216
    s_mov_b32 s55, 0x00020000
    s_mov_b32 s60, s12
    s_mov_b32 s61, s13
    s_mov_b32 s62, 8388608
    s_mov_b32 s63, 0x00020000
    s_mov_b32 s64, s14
    s_mov_b32 s65, s15
    s_mov_b32 s66, 12582912
    s_mov_b32 s67, 0x00020000
    s_mov_b32 s43, s25
    s_and_b32 s42, s21, 0
    s_mul_i32 s42, s42, 65536
    s_add_u32 s25, s43, s42
    s_lshl_b32 s29, s18, 2
    s_add_u32 s29, s29, s19
    s_lshl_b32 s29, s29, 19
    s_lshl_b32 s30, s21, 16
    s_add_u32 s39, s29, s30
    v_lshlrev_b32 v7, 7, v0
    s_lshl_b32 s29, s21, 13
    s_add_u32 s41, s43, s29
    s_mov_b32 s40, 0
    s_cmp_eq_u32 s21, 4
    s_cselect_b32 s40, 6, s40
    s_cmp_eq_u32 s21, 5
    s_cselect_b32 s40, 5, s40
    s_cmp_eq_u32 s21, 6
    s_cselect_b32 s40, 4, s40
    s_cmp_eq_u32 s21, 7
    s_cselect_b32 s40, 3, s40
    s_cmp_ge_u32 s3, 4
    s_cbranch_scc1 L_touch
    s_add_u32 m0, s26, 65536
    s_add_u32 s30, s22, 0
    buffer_load_dwordx4 v84, s[44:47], s30 offen lds
    s_add_u32 m0, s26, 69632
    s_add_u32 s30, s22, 16384
    buffer_load_dwordx4 v84, s[44:47], s30 offen lds
    s_add_u32 m0, s26, 73728
    s_add_u32 s30, s22, 32768
    buffer_load_dwordx4 v84, s[44:47], s30 offen lds
    s_add_u32 m0, s26, 77824
    s_add_u32 s30, s22, 49152
    buffer_load_dwordx4 v84, s[44:47], s30 offen lds
    s_add_u32 m0, s26, 81920
    s_add_u32 s30, s22, 65536
    buffer_load_dwordx4 v84, s[44:47], s30 offen lds
    s_add_u32 m0, s26, 86016
    s_add_u32 s30, s22, 81920
    buffer_load_dwordx4 v84, s[44:47], s30 offen lds
    s_add_u32 m0, s27, 0
    s_add_u32 s30, s23, 0
    buffer_load_dwordx4 v80, s[56:59], s30 offen offset:0 lds
    buffer_load_dwordx4 v81, s[56:59], s30 offen offset:1024 lds
    buffer_load_dwordx4 v82, s[56:59], s30 offen offset:2048 lds
    buffer_load_dwordx4 v83, s[56:59], s30 offen offset:3072 lds
    s_add_u32 m0, s27, 16384
    s_add_u32 s30, s23, 524288
    buffer_load_dwordx4 v80, s[56:59], s30 offen offset:0 lds
    buffer_load_dwordx4 v81, s[56:59], s30 offen offset:1024 lds
    buffer_load_dwordx4 v82, s[56:59], s30 offen offset:2048 lds
    buffer_load_dwordx4 v83, s[56:59], s30 offen offset:3072 lds
    s_add_u32 m0, s27, 32768
    s_add_u32 s30, s23, 1048576
    buffer_load_dwordx4 v80, s[56:59], s30 offen offset:0 lds
    buffer_load_dwordx4 v81, s[56:59], s30 offen offset:1024 lds
    buffer_load_dwordx4 v82, s[56:59], s30 offen offset:2048 lds
    buffer_load_dwordx4 v83, s[56:59], s30 offen offset:3072 lds
    s_add_u32 m0, s26, 90112
    s_add_u32 s30, s22, 512
    buffer_load_dwordx4 v84, s[44:47], s30 offen lds
    s_add_u32 m0, s26, 94208
    s_add_u32 s30, s22, 16896
    buffer_load_dwordx4 v84, s[44:47], s30 offen lds
    s_add_u32 m0, s26, 98304
    s_add_u32 s30, s22, 33280
    buffer_load_dwordx4 v84, s[44:47], s30 offen lds
    s_add_u32 m0, s26, 102400
    s_add_u32 s30, s22, 49664
    buffer_load_dwordx4 v84, s[44:47], s30 offen lds
    s_add_u32 m0, s26, 106496
    s_add_u32 s30, s22, 66048
    buffer_load_dwordx4 v84, s[44:47], s30 offen lds
    s_add_u32 m0, s26, 110592
    s_add_u32 s30, s22, 82432
    buffer_load_dwordx4 v84, s[44:47], s30 offen lds
    v_and_b32 v27, 7, v0
    v_lshlrev_b32 v27, 1, v27
    v_xor_b32 v27, v27, v24
    v_lshlrev_b32 v27, 4, v27
    v_lshl_add_u32 v28, v26, 9, v27
    v_add_u32 v28, 65536, v28
    v_lshl_add_u32 v29, v26, 8, v27
    s_add_u32 s29, s28, 65536
    v_add_u32 v29, s29, v29
    v_xor_b32 v12, 0, v28
    v_xor_b32 v8, 0, v29
    v_mov_b32 v20, 0x3f803f80
    v_xor_b32 v13, 64, v28
    v_xor_b32 v9, 64, v29
    v_mov_b32 v21, 0x3f803f80
    v_xor_b32 v14, 128, v28
    v_xor_b32 v10, 128, v29
    v_mov_b32 v22, 0x3f803f80
    v_xor_b32 v15, 192, v28
    v_xor_b32 v11, 192, v29
    v_mov_b32 v23, 0x3f803f80
    v_bfe_u32 v28, v0, 2, 2
    v_and_b32 v29, 1, v24
    v_lshl_or_b32 v29, v29, 2, v28
    v_xor_b32 v29, s3, v29
    v_lshl_add_u32 v30, v24, 3, v28
    v_lshlrev_b32 v30, 8, v30
    v_lshl_add_u32 v30, v29, 5, v30
    v_and_b32 v31, 3, v0
    v_lshl_add_u32 v16, v31, 3, v30
    s_waitcnt vmcnt(14)
    s_barrier
    ds_read_b64_tr_b16 v[32:33], v16 offset:0
    ds_read_b64_tr_b16 v[34:35], v16 offset:1024
    ds_read_b128 v[40:43], v12 offset:0
    ds_read_b128 v[44:47], v12 offset:8192
    ds_read_b128 v[48:51], v12 offset:16384
    ds_read_b64_tr_b16 v[36:37], v16 offset:8192
    ds_read_b64_tr_b16 v[38:39], v16 offset:9216
    ds_read_b128 v[52:55], v13 offset:0
    ds_read_b128 v[56:59], v13 offset:8192
    ds_read_b128 v[60:63], v13 offset:16384
    s_add_u32 m0, s26, 114688
    s_add_u32 s30, s22, 1024
    buffer_load_dwordx4 v84, s[44:47], s30 offen lds
    s_add_u32 m0, s27, 49152
    s_add_u32 s30, s23, 1572864
    buffer_load_dwordx4 v80, s[56:59], s30 offen offset:0 lds
    buffer_load_dwordx4 v81, s[56:59], s30 offen offset:1024 lds
    buffer_load_dwordx4 v82, s[56:59], s30 offen offset:2048 lds
    buffer_load_dwordx4 v83, s[56:59], s30 offen offset:3072 lds
    s_waitcnt lgkmcnt(0)
    s_waitcnt vmcnt(15)
    s_barrier
    ds_read_b64_tr_b16 v[200:201], v16 offset:16384
    ds_read_b64_tr_b16 v[202:203], v16 offset:17408
    ds_read_b128 v[208:211], v14 offset:0
    ds_read_b128 v[212:215], v14 offset:8192
    ds_read_b128 v[216:219], v14 offset:16384
    ds_read_b64_tr_b16 v[204:205], v16 offset:24576
    ds_read_b64_tr_b16 v[206:207], v16 offset:25600
    ds_read_b128 v[220:223], v15 offset:0
    ds_read_b128 v[224:227], v15 offset:8192
    ds_read_b128 v[228:231], v15 offset:16384
    v_mfma_f32_16x16x32_bf16 v[176:179], v[32:35], v[40:43], 0
    v_mfma_f32_16x16x32_bf16 v[180:183], v[32:35], v[44:47], 0
    v_mfma_f32_16x16x32_bf16 v[184:187], v[32:35], v[48:51], 0
    v_mfma_f32_16x16x32_bf16 v[176:179], v[36:39], v[52:55], v[176:179]
    v_mfma_f32_16x16x32_bf16 v[180:183], v[36:39], v[56:59], v[180:183]
    v_mfma_f32_16x16x32_bf16 v[184:187], v[36:39], v[60:63], v[184:187]
    s_add_u32 m0, s26, 118784
    s_add_u32 s30, s22, 17408
    buffer_load_dwordx4 v84, s[44:47], s30 offen lds
    s_add_u32 m0, s27, 0
    s_add_u32 s30, s23, 2097152
    buffer_load_dwordx4 v80, s[56:59], s30 offen offset:0 lds
    buffer_load_dwordx4 v81, s[56:59], s30 offen offset:1024 lds
    buffer_load_dwordx4 v82, s[56:59], s30 offen offset:2048 lds
    buffer_load_dwordx4 v83, s[56:59], s30 offen offset:3072 lds
    s_waitcnt lgkmcnt(0)
    s_waitcnt vmcnt(16)
    s_barrier
    ds_read_b64_tr_b16 v[32:33], v16 offset:32768
    ds_read_b64_tr_b16 v[34:35], v16 offset:33792
    ds_read_b128 v[40:43], v12 offset:256
    ds_read_b128 v[44:47], v12 offset:8448
    ds_read_b128 v[48:51], v12 offset:16640
    ds_read_b64_tr_b16 v[36:37], v16 offset:40960
    ds_read_b64_tr_b16 v[38:39], v16 offset:41984
    ds_read_b128 v[52:55], v13 offset:256
    ds_read_b128 v[56:59], v13 offset:8448
    ds_read_b128 v[60:63], v13 offset:16640
    v_mfma_f32_16x16x32_bf16 v[176:179], v[200:203], v[208:211], v[176:179]
    v_mfma_f32_16x16x32_bf16 v[180:183], v[200:203], v[212:215], v[180:183]
    v_mfma_f32_16x16x32_bf16 v[184:187], v[200:203], v[216:219], v[184:187]
    v_mfma_f32_16x16x32_bf16 v[176:179], v[204:207], v[220:223], v[176:179]
    v_mfma_f32_16x16x32_bf16 v[180:183], v[204:207], v[224:227], v[180:183]
    v_mfma_f32_16x16x32_bf16 v[184:187], v[204:207], v[228:231], v[184:187]
    s_add_u32 m0, s26, 122880
    s_add_u32 s30, s22, 33792
    buffer_load_dwordx4 v84, s[44:47], s30 offen lds
    s_add_u32 m0, s27, 16384
    s_add_u32 s30, s23, 2621440
    buffer_load_dwordx4 v80, s[56:59], s30 offen offset:0 lds
    buffer_load_dwordx4 v81, s[56:59], s30 offen offset:1024 lds
    buffer_load_dwordx4 v82, s[56:59], s30 offen offset:2048 lds
    buffer_load_dwordx4 v83, s[56:59], s30 offen offset:3072 lds
    s_waitcnt lgkmcnt(0)
    s_waitcnt vmcnt(10)
    s_barrier
    ds_read_b64_tr_b16 v[200:201], v16 offset:49152
    ds_read_b64_tr_b16 v[202:203], v16 offset:50176
    ds_read_b128 v[208:211], v14 offset:256
    ds_read_b128 v[212:215], v14 offset:8448
    ds_read_b128 v[216:219], v14 offset:16640
    ds_read_b64_tr_b16 v[204:205], v16 offset:57344
    ds_read_b64_tr_b16 v[206:207], v16 offset:58368
    ds_read_b128 v[220:223], v15 offset:256
    ds_read_b128 v[224:227], v15 offset:8448
    ds_read_b128 v[228:231], v15 offset:16640
    v_mfma_f32_16x16x32_bf16 v[176:179], v[32:35], v[40:43], v[176:179]
    v_mfma_f32_16x16x32_bf16 v[180:183], v[32:35], v[44:47], v[180:183]
    v_mfma_f32_16x16x32_bf16 v[184:187], v[32:35], v[48:51], v[184:187]
    v_mfma_f32_16x16x32_bf16 v[176:179], v[36:39], v[52:55], v[176:179]
    v_mfma_f32_16x16x32_bf16 v[180:183], v[36:39], v[56:59], v[180:183]
    v_mfma_f32_16x16x32_bf16 v[184:187], v[36:39], v[60:63], v[184:187]
    s_add_u32 m0, s26, 126976
    s_add_u32 s30, s22, 50176
    buffer_load_dwordx4 v84, s[44:47], s30 offen lds
    s_add_u32 m0, s27, 32768
    s_add_u32 s30, s23, 3145728
    buffer_load_dwordx4 v80, s[56:59], s30 offen offset:0 lds
    buffer_load_dwordx4 v81, s[56:59], s30 offen offset:1024 lds
    buffer_load_dwordx4 v82, s[56:59], s30 offen offset:2048 lds
    buffer_load_dwordx4 v83, s[56:59], s30 offen offset:3072 lds
    s_waitcnt lgkmcnt(0)
    s_waitcnt vmcnt(10)
    s_barrier
    v_add_u32 v12, 24576, v12
    v_add_u32 v13, 24576, v13
    v_add_u32 v14, 24576, v14
    v_add_u32 v15, 24576, v15
    ds_read_b64_tr_b16 v[32:33], v16 offset:0
    ds_read_b64_tr_b16 v[34:35], v16 offset:1024
    ds_read_b128 v[40:43], v12 offset:0
    ds_read_b128 v[44:47], v12 offset:8192
    ds_read_b128 v[48:51], v12 offset:16384
    ds_read_b64_tr_b16 v[36:37], v16 offset:8192
    ds_read_b64_tr_b16 v[38:39], v16 offset:9216
    ds_read_b128 v[52:55], v13 offset:0
    ds_read_b128 v[56:59], v13 offset:8192
    ds_read_b128 v[60:63], v13 offset:16384
    v_mfma_f32_16x16x32_bf16 v[176:179], v[200:203], v[208:211], v[176:179]
    v_mfma_f32_16x16x32_bf16 v[180:183], v[200:203], v[212:215], v[180:183]
    v_mfma_f32_16x16x32_bf16 v[184:187], v[200:203], v[216:219], v[184:187]
    v_mfma_f32_16x16x32_bf16 v[176:179], v[204:207], v[220:223], v[176:179]
    v_mfma_f32_16x16x32_bf16 v[180:183], v[204:207], v[224:227], v[180:183]
    v_mfma_f32_16x16x32_bf16 v[184:187], v[204:207], v[228:231], v[184:187]
    s_add_u32 m0, s26, 131072
    s_add_u32 s30, s22, 66560
    buffer_load_dwordx4 v84, s[44:47], s30 offen lds
    s_add_u32 m0, s26, 139264
    s_add_u32 s30, s22, 1536
    buffer_load_dwordx4 v84, s[44:47], s30 offen lds
    s_add_u32 m0, s27, 49152
    s_add_u32 s30, s23, 3670016
    buffer_load_dwordx4 v80, s[56:59], s30 offen offset:0 lds
    buffer_load_dwordx4 v81, s[56:59], s30 offen offset:1024 lds
    buffer_load_dwordx4 v82, s[56:59], s30 offen offset:2048 lds
    buffer_load_dwordx4 v83, s[56:59], s30 offen offset:3072 lds
    s_cmp_lg_u32 s21, 0
    s_cbranch_scc1 L_st1
    buffer_load_dword v1, v7, s[48:51], s41 offen
    buffer_load_dword v1, v7, s[52:55], s41 offen
L_st1:
    s_waitcnt lgkmcnt(0)
    s_waitcnt vmcnt(11)
    s_barrier
    ds_read_b64_tr_b16 v[200:201], v16 offset:16384
    ds_read_b64_tr_b16 v[202:203], v16 offset:17408
    ds_read_b128 v[208:211], v14 offset:0
    ds_read_b128 v[212:215], v14 offset:8192
    ds_read_b128 v[216:219], v14 offset:16384
    ds_read_b64_tr_b16 v[204:205], v16 offset:24576
    ds_read_b64_tr_b16 v[206:207], v16 offset:25600
    ds_read_b128 v[220:223], v15 offset:0
    ds_read_b128 v[224:227], v15 offset:8192
    ds_read_b128 v[228:231], v15 offset:16384
    v_mfma_f32_16x16x32_bf16 v[176:179], v[32:35], v[40:43], v[176:179]
    v_mfma_f32_16x16x32_bf16 v[180:183], v[32:35], v[44:47], v[180:183]
    v_mfma_f32_16x16x32_bf16 v[184:187], v[32:35], v[48:51], v[184:187]
    v_mfma_f32_16x16x32_bf16 v[176:179], v[36:39], v[52:55], v[176:179]
    v_mfma_f32_16x16x32_bf16 v[180:183], v[36:39], v[56:59], v[180:183]
    v_mfma_f32_16x16x32_bf16 v[184:187], v[36:39], v[60:63], v[184:187]
    s_add_u32 m0, s26, 135168
    s_add_u32 s30, s22, 82944
    buffer_load_dwordx4 v84, s[44:47], s30 offen lds
    s_add_u32 m0, s26, 143360
    s_add_u32 s30, s22, 17920
    buffer_load_dwordx4 v84, s[44:47], s30 offen lds
    s_add_u32 m0, s27, 0
    s_add_u32 s30, s23, 4194304
    buffer_load_dwordx4 v80, s[56:59], s30 offen offset:0 lds
    buffer_load_dwordx4 v81, s[56:59], s30 offen offset:1024 lds
    buffer_load_dwordx4 v82, s[56:59], s30 offen offset:2048 lds
    buffer_load_dwordx4 v83, s[56:59], s30 offen offset:3072 lds
    s_waitcnt lgkmcnt(0)
    s_waitcnt vmcnt(12)
    s_barrier
    ds_read_b64_tr_b16 v[32:33], v16 offset:32768
    ds_read_b64_tr_b16 v[34:35], v16 offset:33792
    ds_read_b128 v[40:43], v12 offset:256
    ds_read_b128 v[44:47], v12 offset:8448
    ds_read_b128 v[48:51], v12 offset:16640
    ds_read_b64_tr_b16 v[36:37], v16 offset:40960
    ds_read_b64_tr_b16 v[38:39], v16 offset:41984
    ds_read_b128 v[52:55], v13 offset:256
    ds_read_b128 v[56:59], v13 offset:8448
    ds_read_b128 v[60:63], v13 offset:16640
    v_mfma_f32_16x16x32_bf16 v[176:179], v[200:203], v[208:211], v[176:179]
    v_mfma_f32_16x16x32_bf16 v[180:183], v[200:203], v[212:215], v[180:183]
    v_mfma_f32_16x16x32_bf16 v[184:187], v[200:203], v[216:219], v[184:187]
    v_mfma_f32_16x16x32_bf16 v[176:179], v[204:207], v[220:223], v[176:179]
    v_mfma_f32_16x16x32_bf16 v[180:183], v[204:207], v[224:227], v[180:183]
    v_mfma_f32_16x16x32_bf16 v[184:187], v[204:207], v[228:231], v[184:187]
    s_add_u32 m0, s26, 147456
    s_add_u32 s30, s22, 34304
    buffer_load_dwordx4 v84, s[44:47], s30 offen lds
    s_add_u32 m0, s27, 16384
    s_add_u32 s30, s23, 4718592
    buffer_load_dwordx4 v80, s[56:59], s30 offen offset:0 lds
    buffer_load_dwordx4 v81, s[56:59], s30 offen offset:1024 lds
    buffer_load_dwordx4 v82, s[56:59], s30 offen offset:2048 lds
    buffer_load_dwordx4 v83, s[56:59], s30 offen offset:3072 lds
    s_waitcnt lgkmcnt(0)
    s_waitcnt vmcnt(11)
    s_barrier
    ds_read_b64_tr_b16 v[200:201], v16 offset:49152
    ds_read_b64_tr_b16 v[202:203], v16 offset:50176
    ds_read_b128 v[208:211], v14 offset:256
    ds_read_b128 v[212:215], v14 offset:8448
    ds_read_b128 v[216:219], v14 offset:16640
    ds_read_b64_tr_b16 v[204:205], v16 offset:57344
    ds_read_b64_tr_b16 v[206:207], v16 offset:58368
    ds_read_b128 v[220:223], v15 offset:256
    ds_read_b128 v[224:227], v15 offset:8448
    ds_read_b128 v[228:231], v15 offset:16640
    v_mfma_f32_16x16x32_bf16 v[176:179], v[32:35], v[40:43], v[176:179]
    v_mfma_f32_16x16x32_bf16 v[180:183], v[32:35], v[44:47], v[180:183]
    v_mfma_f32_16x16x32_bf16 v[184:187], v[32:35], v[48:51], v[184:187]
    v_mfma_f32_16x16x32_bf16 v[176:179], v[36:39], v[52:55], v[176:179]
    v_mfma_f32_16x16x32_bf16 v[180:183], v[36:39], v[56:59], v[180:183]
    v_mfma_f32_16x16x32_bf16 v[184:187], v[36:39], v[60:63], v[184:187]
    s_add_u32 m0, s26, 151552
    s_add_u32 s30, s22, 50688
    buffer_load_dwordx4 v84, s[44:47], s30 offen lds
    s_add_u32 m0, s27, 32768
    s_add_u32 s30, s23, 5242880
    buffer_load_dwordx4 v80, s[56:59], s30 offen offset:0 lds
    buffer_load_dwordx4 v81, s[56:59], s30 offen offset:1024 lds
    buffer_load_dwordx4 v82, s[56:59], s30 offen offset:2048 lds
    buffer_load_dwordx4 v83, s[56:59], s30 offen offset:3072 lds
    s_waitcnt lgkmcnt(0)
    s_waitcnt vmcnt(10)
    s_barrier
    v_add_u32 v12, 24576, v12
    v_add_u32 v13, 24576, v13
    v_add_u32 v14, 24576, v14
    v_add_u32 v15, 24576, v15
    ds_read_b64_tr_b16 v[32:33], v16 offset:0
    ds_read_b64_tr_b16 v[34:35], v16 offset:1024
    ds_read_b128 v[40:43], v12 offset:0
    ds_read_b128 v[44:47], v12 offset:8192
    ds_read_b128 v[48:51], v12 offset:16384
    ds_read_b64_tr_b16 v[36:37], v16 offset:8192
    ds_read_b64_tr_b16 v[38:39], v16 offset:9216
    ds_read_b128 v[52:55], v13 offset:0
    ds_read_b128 v[56:59], v13 offset:8192
    ds_read_b128 v[60:63], v13 offset:16384
    v_mfma_f32_16x16x32_bf16 v[176:179], v[200:203], v[208:211], v[176:179]
    v_mfma_f32_16x16x32_bf16 v[180:183], v[200:203], v[212:215], v[180:183]
    v_mfma_f32_16x16x32_bf16 v[184:187], v[200:203], v[216:219], v[184:187]
    v_mfma_f32_16x16x32_bf16 v[176:179], v[204:207], v[220:223], v[176:179]
    v_mfma_f32_16x16x32_bf16 v[180:183], v[204:207], v[224:227], v[180:183]
    v_mfma_f32_16x16x32_bf16 v[184:187], v[204:207], v[228:231], v[184:187]
    s_add_u32 m0, s26, 155648
    s_add_u32 s30, s22, 67072
    buffer_load_dwordx4 v84, s[44:47], s30 offen lds
    s_add_u32 m0, s27, 49152
    s_add_u32 s30, s23, 5767168
    buffer_load_dwordx4 v80, s[56:59], s30 offen offset:0 lds
    buffer_load_dwordx4 v81, s[56:59], s30 offen offset:1024 lds
    buffer_load_dwordx4 v82, s[56:59], s30 offen offset:2048 lds
    buffer_load_dwordx4 v83, s[56:59], s30 offen offset:3072 lds
    s_cmp_lg_u32 s21, 1
    s_cbranch_scc1 L_st2
    buffer_load_dword v1, v7, s[48:51], s41 offen
    buffer_load_dword v1, v7, s[52:55], s41 offen
L_st2:
    s_waitcnt lgkmcnt(0)
    s_waitcnt vmcnt(10)
    s_barrier
    ds_read_b64_tr_b16 v[200:201], v16 offset:16384
    ds_read_b64_tr_b16 v[202:203], v16 offset:17408
    ds_read_b128 v[208:211], v14 offset:0
    ds_read_b128 v[212:215], v14 offset:8192
    ds_read_b128 v[216:219], v14 offset:16384
    ds_read_b64_tr_b16 v[204:205], v16 offset:24576
    ds_read_b64_tr_b16 v[206:207], v16 offset:25600
    ds_read_b128 v[220:223], v15 offset:0
    ds_read_b128 v[224:227], v15 offset:8192
    ds_read_b128 v[228:231], v15 offset:16384
    v_mfma_f32_16x16x32_bf16 v[176:179], v[32:35], v[40:43], v[176:179]
    v_mfma_f32_16x16x32_bf16 v[180:183], v[32:35], v[44:47], v[180:183]
    v_mfma_f32_16x16x32_bf16 v[184:187], v[32:35], v[48:51], v[184:187]
    v_mfma_f32_16x16x32_bf16 v[176:179], v[36:39], v[52:55], v[176:179]
    v_mfma_f32_16x16x32_bf16 v[180:183], v[36:39], v[56:59], v[180:183]
    v_mfma_f32_16x16x32_bf16 v[184:187], v[36:39], v[60:63], v[184:187]
    s_add_u32 m0, s26, 159744
    s_add_u32 s30, s22, 83456
    buffer_load_dwordx4 v84, s[44:47], s30 offen lds
    s_add_u32 m0, s27, 0
    s_add_u32 s30, s23, 6291456
    buffer_load_dwordx4 v80, s[56:59], s30 offen offset:0 lds
    buffer_load_dwordx4 v81, s[56:59], s30 offen offset:1024 lds
    buffer_load_dwordx4 v82, s[56:59], s30 offen offset:2048 lds
    buffer_load_dwordx4 v83, s[56:59], s30 offen offset:3072 lds
    s_waitcnt lgkmcnt(0)
    s_waitcnt vmcnt(10)
    s_barrier
    ds_read_b64_tr_b16 v[32:33], v16 offset:32768
    ds_read_b64_tr_b16 v[34:35], v16 offset:33792
    ds_read_b128 v[40:43], v12 offset:256
    ds_read_b128 v[44:47], v12 offset:8448
    ds_read_b128 v[48:51], v12 offset:16640
    ds_read_b64_tr_b16 v[36:37], v16 offset:40960
    ds_read_b64_tr_b16 v[38:39], v16 offset:41984
    ds_read_b128 v[52:55], v13 offset:256
    ds_read_b128 v[56:59], v13 offset:8448
    ds_read_b128 v[60:63], v13 offset:16640
    v_mfma_f32_16x16x32_bf16 v[176:179], v[200:203], v[208:211], v[176:179]
    v_mfma_f32_16x16x32_bf16 v[180:183], v[200:203], v[212:215], v[180:183]
    v_mfma_f32_16x16x32_bf16 v[184:187], v[200:203], v[216:219], v[184:187]
    v_mfma_f32_16x16x32_bf16 v[176:179], v[204:207], v[220:223], v[176:179]
    v_mfma_f32_16x16x32_bf16 v[180:183], v[204:207], v[224:227], v[180:183]
    v_mfma_f32_16x16x32_bf16 v[184:187], v[204:207], v[228:231], v[184:187]
    s_add_u32 m0, s27, 16384
    s_add_u32 s30, s23, 6815744
    buffer_load_dwordx4 v80, s[56:59], s30 offen offset:0 lds
    buffer_load_dwordx4 v81, s[56:59], s30 offen offset:1024 lds
    buffer_load_dwordx4 v82, s[56:59], s30 offen offset:2048 lds
    buffer_load_dwordx4 v83, s[56:59], s30 offen offset:3072 lds
    s_waitcnt lgkmcnt(0)
    s_waitcnt vmcnt(9)
    s_barrier
    ds_read_b64_tr_b16 v[200:201], v16 offset:49152
    ds_read_b64_tr_b16 v[202:203], v16 offset:50176
    ds_read_b128 v[208:211], v14 offset:256
    ds_read_b128 v[212:215], v14 offset:8448
    ds_read_b128 v[216:219], v14 offset:16640
    ds_read_b64_tr_b16 v[204:205], v16 offset:57344
    ds_read_b64_tr_b16 v[206:207], v16 offset:58368
    ds_read_b128 v[220:223], v15 offset:256
    ds_read_b128 v[224:227], v15 offset:8448
    ds_read_b128 v[228:231], v15 offset:16640
    v_mfma_f32_16x16x32_bf16 v[176:179], v[32:35], v[40:43], v[176:179]
    v_mfma_f32_16x16x32_bf16 v[180:183], v[32:35], v[44:47], v[180:183]
    v_mfma_f32_16x16x32_bf16 v[184:187], v[32:35], v[48:51], v[184:187]
    v_mfma_f32_16x16x32_bf16 v[176:179], v[36:39], v[52:55], v[176:179]
    v_mfma_f32_16x16x32_bf16 v[180:183], v[36:39], v[56:59], v[180:183]
    v_mfma_f32_16x16x32_bf16 v[184:187], v[36:39], v[60:63], v[184:187]
    s_add_u32 m0, s27, 32768
    s_add_u32 s30, s23, 7340032
    buffer_load_dwordx4 v80, s[56:59], s30 offen offset:0 lds
    buffer_load_dwordx4 v81, s[56:59], s30 offen offset:1024 lds
    buffer_load_dwordx4 v82, s[56:59], s30 offen offset:2048 lds
    buffer_load_dwordx4 v83, s[56:59], s30 offen offset:3072 lds
    s_waitcnt lgkmcnt(0)
    s_waitcnt vmcnt(8)
    s_barrier
    v_add_u32 v12, 24576, v12
    v_add_u32 v13, 24576, v13
    v_add_u32 v14, 24576, v14
    v_add_u32 v15, 24576, v15
    ds_read_b64_tr_b16 v[32:33], v16 offset:0
    ds_read_b64_tr_b16 v[34:35], v16 offset:1024
    ds_read_b128 v[40:43], v12 offset:0
    ds_read_b128 v[44:47], v12 offset:8192
    ds_read_b128 v[48:51], v12 offset:16384
    ds_read_b64_tr_b16 v[36:37], v16 offset:8192
    ds_read_b64_tr_b16 v[38:39], v16 offset:9216
    ds_read_b128 v[52:55], v13 offset:0
    ds_read_b128 v[56:59], v13 offset:8192
    ds_read_b128 v[60:63], v13 offset:16384
    v_mfma_f32_16x16x32_bf16 v[176:179], v[200:203], v[208:211], v[176:179]
    v_mfma_f32_16x16x32_bf16 v[180:183], v[200:203], v[212:215], v[180:183]
    v_mfma_f32_16x16x32_bf16 v[184:187], v[200:203], v[216:219], v[184:187]
    v_mfma_f32_16x16x32_bf16 v[176:179], v[204:207], v[220:223], v[176:179]
    v_mfma_f32_16x16x32_bf16 v[180:183], v[204:207], v[224:227], v[180:183]
    v_mfma_f32_16x16x32_bf16 v[184:187], v[204:207], v[228:231], v[184:187]
    s_add_u32 m0, s27, 49152
    s_add_u32 s30, s23, 7864320
    buffer_load_dwordx4 v80, s[56:59], s30 offen offset:0 lds
    buffer_load_dwordx4 v81, s[56:59], s30 offen offset:1024 lds
    buffer_load_dwordx4 v82, s[56:59], s30 offen offset:2048 lds
    buffer_load_dwordx4 v83, s[56:59], s30 offen offset:3072 lds
    s_cmp_lg_u32 s21, 2
    s_cbranch_scc1 L_st3
    buffer_load_dword v1, v7, s[48:51], s41 offen
    buffer_load_dword v1, v7, s[52:55], s41 offen
L_st3:
    s_add_u32 m0, s28, 65536
    s_add_u32 s30, s25, 0
    buffer_load_dwordx4 v2, s[48:51], s30 offen offset:0 lds
    buffer_load_dwordx4 v3, s[48:51], s30 offen offset:1024 lds
    buffer_load_dwordx4 v2, s[48:51], s30 offen offset:2048 lds
    buffer_load_dwordx4 v3, s[48:51], s30 offen offset:3072 lds
    s_waitcnt lgkmcnt(0)
    s_waitcnt vmcnt(12)
    s_barrier
    ds_read_b64_tr_b16 v[200:201], v16 offset:16384
    ds_read_b64_tr_b16 v[202:203], v16 offset:17408
    ds_read_b128 v[208:211], v14 offset:0
    ds_read_b128 v[212:215], v14 offset:8192
    ds_read_b128 v[216:219], v14 offset:16384
    ds_read_b64_tr_b16 v[204:205], v16 offset:24576
    ds_read_b64_tr_b16 v[206:207], v16 offset:25600
    ds_read_b128 v[220:223], v15 offset:0
    ds_read_b128 v[224:227], v15 offset:8192
    ds_read_b128 v[228:231], v15 offset:16384
    v_mfma_f32_16x16x32_bf16 v[176:179], v[32:35], v[40:43], v[176:179]
    v_mfma_f32_16x16x32_bf16 v[180:183], v[32:35], v[44:47], v[180:183]
    v_mfma_f32_16x16x32_bf16 v[184:187], v[32:35], v[48:51], v[184:187]
    v_mfma_f32_16x16x32_bf16 v[176:179], v[36:39], v[52:55], v[176:179]
    v_mfma_f32_16x16x32_bf16 v[180:183], v[36:39], v[56:59], v[180:183]
    v_mfma_f32_16x16x32_bf16 v[184:187], v[36:39], v[60:63], v[184:187]
    s_add_u32 m0, s28, 98304
    s_add_u32 s30, s25, 4096
    buffer_load_dwordx4 v2, s[48:51], s30 offen offset:0 lds
    buffer_load_dwordx4 v3, s[48:51], s30 offen offset:1024 lds
    buffer_load_dwordx4 v2, s[48:51], s30 offen offset:2048 lds
    buffer_load_dwordx4 v3, s[48:51], s30 offen offset:3072 lds
    s_waitcnt lgkmcnt(0)
    s_waitcnt vmcnt(12)
    s_barrier
    ds_read_b64_tr_b16 v[32:33], v16 offset:32768
    ds_read_b64_tr_b16 v[34:35], v16 offset:33792
    ds_read_b128 v[40:43], v12 offset:256
    ds_read_b128 v[44:47], v12 offset:8448
    ds_read_b128 v[48:51], v12 offset:16640
    ds_read_b64_tr_b16 v[36:37], v16 offset:40960
    ds_read_b64_tr_b16 v[38:39], v16 offset:41984
    ds_read_b128 v[52:55], v13 offset:256
    ds_read_b128 v[56:59], v13 offset:8448
    ds_read_b128 v[60:63], v13 offset:16640
    v_mfma_f32_16x16x32_bf16 v[176:179], v[200:203], v[208:211], v[176:179]
    v_mfma_f32_16x16x32_bf16 v[180:183], v[200:203], v[212:215], v[180:183]
    v_mfma_f32_16x16x32_bf16 v[184:187], v[200:203], v[216:219], v[184:187]
    v_mfma_f32_16x16x32_bf16 v[176:179], v[204:207], v[220:223], v[176:179]
    v_mfma_f32_16x16x32_bf16 v[180:183], v[204:207], v[224:227], v[180:183]
    v_mfma_f32_16x16x32_bf16 v[184:187], v[204:207], v[228:231], v[184:187]
    s_add_u32 m0, s28, 0
    s_add_u32 s30, s25, 0
    buffer_load_dwordx4 v2, s[52:55], s30 offen offset:0 lds
    buffer_load_dwordx4 v3, s[52:55], s30 offen offset:1024 lds
    buffer_load_dwordx4 v2, s[52:55], s30 offen offset:2048 lds
    buffer_load_dwordx4 v3, s[52:55], s30 offen offset:3072 lds
    s_waitcnt lgkmcnt(0)
    s_waitcnt vmcnt(12)
    s_barrier
    ds_read_b64_tr_b16 v[200:201], v16 offset:49152
    ds_read_b64_tr_b16 v[202:203], v16 offset:50176
    ds_read_b128 v[208:211], v14 offset:256
    ds_read_b128 v[212:215], v14 offset:8448
    ds_read_b128 v[216:219], v14 offset:16640
    ds_read_b64_tr_b16 v[204:205], v16 offset:57344
    ds_read_b64_tr_b16 v[206:207], v16 offset:58368
    ds_read_b128 v[220:223], v15 offset:256
    ds_read_b128 v[224:227], v15 offset:8448
    ds_read_b128 v[228:231], v15 offset:16640
    v_mfma_f32_16x16x32_bf16 v[176:179], v[32:35], v[40:43], v[176:179]
    v_mfma_f32_16x16x32_bf16 v[180:183], v[32:35], v[44:47], v[180:183]
    v_mfma_f32_16x16x32_bf16 v[184:187], v[32:35], v[48:51], v[184:187]
    v_mfma_f32_16x16x32_bf16 v[176:179], v[36:39], v[52:55], v[176:179]
    v_mfma_f32_16x16x32_bf16 v[180:183], v[36:39], v[56:59], v[180:183]
    v_mfma_f32_16x16x32_bf16 v[184:187], v[36:39], v[60:63], v[184:187]
    s_waitcnt lgkmcnt(0)
    v_mfma_f32_16x16x32_bf16 v[176:179], v[200:203], v[208:211], v[176:179]
    v_mfma_f32_16x16x32_bf16 v[180:183], v[200:203], v[212:215], v[180:183]
    v_mfma_f32_16x16x32_bf16 v[184:187], v[200:203], v[216:219], v[184:187]
    v_mfma_f32_16x16x32_bf16 v[176:179], v[204:207], v[220:223], v[176:179]
    v_mfma_f32_16x16x32_bf16 v[180:183], v[204:207], v[224:227], v[180:183]
    v_mfma_f32_16x16x32_bf16 v[184:187], v[204:207], v[228:231], v[184:187]
    s_branch L_qdone
L_touch:
    v_and_b32 v27, 7, v0
    v_lshlrev_b32 v27, 1, v27
    v_xor_b32 v27, v27, v24
    v_lshlrev_b32 v27, 4, v27
    v_lshl_add_u32 v28, v26, 9, v27
    v_add_u32 v28, 65536, v28
    v_lshl_add_u32 v29, v26, 8, v27
    s_add_u32 s29, s28, 65536
    v_add_u32 v29, s29, v29
    v_xor_b32 v12, 0, v28
    v_xor_b32 v8, 0, v29
    v_mov_b32 v20, 0x3f803f80
    v_xor_b32 v13, 64, v28
    v_xor_b32 v9, 64, v29
    v_mov_b32 v21, 0x3f803f80
    v_xor_b32 v14, 128, v28
    v_xor_b32 v10, 128, v29
    v_mov_b32 v22, 0x3f803f80
    v_xor_b32 v15, 192, v28
    v_xor_b32 v11, 192, v29
    v_mov_b32 v23, 0x3f803f80
    v_bfe_u32 v28, v0, 2, 2
    v_and_b32 v29, 1, v24
    v_lshl_or_b32 v29, v29, 2, v28
    v_xor_b32 v29, s3, v29
    v_lshl_add_u32 v30, v24, 3, v28
    v_lshlrev_b32 v30, 8, v30
    v_lshl_add_u32 v30, v29, 5, v30
    v_and_b32 v31, 3, v0
    v_lshl_add_u32 v16, v31, 3, v30
    s_barrier
    ds_read_b64_tr_b16 v[32:33], v16 offset:0
    ds_read_b64_tr_b16 v[34:35], v16 offset:1024
    ds_read_b128 v[40:43], v12 offset:0
    ds_read_b128 v[44:47], v12 offset:8192
    ds_read_b128 v[48:51], v12 offset:16384
    ds_read_b64_tr_b16 v[36:37], v16 offset:8192
    ds_read_b64_tr_b16 v[38:39], v16 offset:9216
    ds_read_b128 v[52:55], v13 offset:0
    ds_read_b128 v[56:59], v13 offset:8192
    ds_read_b128 v[60:63], v13 offset:16384
    s_waitcnt lgkmcnt(0)
    s_barrier
    ds_read_b64_tr_b16 v[200:201], v16 offset:16384
    ds_read_b64_tr_b16 v[202:203], v16 offset:17408
    ds_read_b128 v[208:211], v14 offset:0
    ds_read_b128 v[212:215], v14 offset:8192
    ds_read_b128 v[216:219], v14 offset:16384
    ds_read_b64_tr_b16 v[204:205], v16 offset:24576
    ds_read_b64_tr_b16 v[206:207], v16 offset:25600
    ds_read_b128 v[220:223], v15 offset:0
    ds_read_b128 v[224:227], v15 offset:8192
    ds_read_b128 v[228:231], v15 offset:16384
    v_mfma_f32_16x16x32_bf16 v[176:179], v[32:35], v[40:43], 0
    v_mfma_f32_16x16x32_bf16 v[180:183], v[32:35], v[44:47], 0
    v_mfma_f32_16x16x32_bf16 v[184:187], v[32:35], v[48:51], 0
    v_mfma_f32_16x16x32_bf16 v[176:179], v[36:39], v[52:55], v[176:179]
    v_mfma_f32_16x16x32_bf16 v[180:183], v[36:39], v[56:59], v[180:183]
    v_mfma_f32_16x16x32_bf16 v[184:187], v[36:39], v[60:63], v[184:187]
    s_waitcnt lgkmcnt(0)
    s_barrier
    ds_read_b64_tr_b16 v[32:33], v16 offset:32768
    ds_read_b64_tr_b16 v[34:35], v16 offset:33792
    ds_read_b128 v[40:43], v12 offset:256
    ds_read_b128 v[44:47], v12 offset:8448
    ds_read_b128 v[48:51], v12 offset:16640
    ds_read_b64_tr_b16 v[36:37], v16 offset:40960
    ds_read_b64_tr_b16 v[38:39], v16 offset:41984
    ds_read_b128 v[52:55], v13 offset:256
    ds_read_b128 v[56:59], v13 offset:8448
    ds_read_b128 v[60:63], v13 offset:16640
    v_mfma_f32_16x16x32_bf16 v[176:179], v[200:203], v[208:211], v[176:179]
    v_mfma_f32_16x16x32_bf16 v[180:183], v[200:203], v[212:215], v[180:183]
    v_mfma_f32_16x16x32_bf16 v[184:187], v[200:203], v[216:219], v[184:187]
    v_mfma_f32_16x16x32_bf16 v[176:179], v[204:207], v[220:223], v[176:179]
    v_mfma_f32_16x16x32_bf16 v[180:183], v[204:207], v[224:227], v[180:183]
    v_mfma_f32_16x16x32_bf16 v[184:187], v[204:207], v[228:231], v[184:187]
    s_waitcnt lgkmcnt(0)
    s_barrier
    ds_read_b64_tr_b16 v[200:201], v16 offset:49152
    ds_read_b64_tr_b16 v[202:203], v16 offset:50176
    ds_read_b128 v[208:211], v14 offset:256
    ds_read_b128 v[212:215], v14 offset:8448
    ds_read_b128 v[216:219], v14 offset:16640
    ds_read_b64_tr_b16 v[204:205], v16 offset:57344
    ds_read_b64_tr_b16 v[206:207], v16 offset:58368
    ds_read_b128 v[220:223], v15 offset:256
    ds_read_b128 v[224:227], v15 offset:8448
    ds_read_b128 v[228:231], v15 offset:16640
    v_mfma_f32_16x16x32_bf16 v[176:179], v[32:35], v[40:43], v[176:179]
    v_mfma_f32_16x16x32_bf16 v[180:183], v[32:35], v[44:47], v[180:183]
    v_mfma_f32_16x16x32_bf16 v[184:187], v[32:35], v[48:51], v[184:187]
    v_mfma_f32_16x16x32_bf16 v[176:179], v[36:39], v[52:55], v[176:179]
    v_mfma_f32_16x16x32_bf16 v[180:183], v[36:39], v[56:59], v[180:183]
    v_mfma_f32_16x16x32_bf16 v[184:187], v[36:39], v[60:63], v[184:187]
    s_waitcnt lgkmcnt(0)
    s_barrier
    v_add_u32 v12, 24576, v12
    v_add_u32 v13, 24576, v13
    v_add_u32 v14, 24576, v14
    v_add_u32 v15, 24576, v15
    ds_read_b64_tr_b16 v[32:33], v16 offset:0
    ds_read_b64_tr_b16 v[34:35], v16 offset:1024
    ds_read_b128 v[40:43], v12 offset:0
    ds_read_b128 v[44:47], v12 offset:8192
    ds_read_b128 v[48:51], v12 offset:16384
    ds_read_b64_tr_b16 v[36:37], v16 offset:8192
    ds_read_b64_tr_b16 v[38:39], v16 offset:9216
    ds_read_b128 v[52:55], v13 offset:0
    ds_read_b128 v[56:59], v13 offset:8192
    ds_read_b128 v[60:63], v13 offset:16384
    v_mfma_f32_16x16x32_bf16 v[176:179], v[200:203], v[208:211], v[176:179]
    v_mfma_f32_16x16x32_bf16 v[180:183], v[200:203], v[212:215], v[180:183]
    v_mfma_f32_16x16x32_bf16 v[184:187], v[200:203], v[216:219], v[184:187]
    v_mfma_f32_16x16x32_bf16 v[176:179], v[204:207], v[220:223], v[176:179]
    v_mfma_f32_16x16x32_bf16 v[180:183], v[204:207], v[224:227], v[180:183]
    v_mfma_f32_16x16x32_bf16 v[184:187], v[204:207], v[228:231], v[184:187]
    s_cmp_lg_u32 s21, 0
    s_cbranch_scc1 L_st4
    buffer_load_dword v1, v7, s[48:51], s41 offen
    buffer_load_dword v1, v7, s[52:55], s41 offen
L_st4:
    s_waitcnt lgkmcnt(0)
    s_barrier
    ds_read_b64_tr_b16 v[200:201], v16 offset:16384
    ds_read_b64_tr_b16 v[202:203], v16 offset:17408
    ds_read_b128 v[208:211], v14 offset:0
    ds_read_b128 v[212:215], v14 offset:8192
    ds_read_b128 v[216:219], v14 offset:16384
    ds_read_b64_tr_b16 v[204:205], v16 offset:24576
    ds_read_b64_tr_b16 v[206:207], v16 offset:25600
    ds_read_b128 v[220:223], v15 offset:0
    ds_read_b128 v[224:227], v15 offset:8192
    ds_read_b128 v[228:231], v15 offset:16384
    v_mfma_f32_16x16x32_bf16 v[176:179], v[32:35], v[40:43], v[176:179]
    v_mfma_f32_16x16x32_bf16 v[180:183], v[32:35], v[44:47], v[180:183]
    v_mfma_f32_16x16x32_bf16 v[184:187], v[32:35], v[48:51], v[184:187]
    v_mfma_f32_16x16x32_bf16 v[176:179], v[36:39], v[52:55], v[176:179]
    v_mfma_f32_16x16x32_bf16 v[180:183], v[36:39], v[56:59], v[180:183]
    v_mfma_f32_16x16x32_bf16 v[184:187], v[36:39], v[60:63], v[184:187]
    s_waitcnt lgkmcnt(0)
    s_barrier
    ds_read_b64_tr_b16 v[32:33], v16 offset:32768
    ds_read_b64_tr_b16 v[34:35], v16 offset:33792
    ds_read_b128 v[40:43], v12 offset:256
    ds_read_b128 v[44:47], v12 offset:8448
    ds_read_b128 v[48:51], v12 offset:16640
    ds_read_b64_tr_b16 v[36:37], v16 offset:40960
    ds_read_b64_tr_b16 v[38:39], v16 offset:41984
    ds_read_b128 v[52:55], v13 offset:256
    ds_read_b128 v[56:59], v13 offset:8448
    ds_read_b128 v[60:63], v13 offset:16640
    v_mfma_f32_16x16x32_bf16 v[176:179], v[200:203], v[208:211], v[176:179]
    v_mfma_f32_16x16x32_bf16 v[180:183], v[200:203], v[212:215], v[180:183]
    v_mfma_f32_16x16x32_bf16 v[184:187], v[200:203], v[216:219], v[184:187]
    v_mfma_f32_16x16x32_bf16 v[176:179], v[204:207], v[220:223], v[176:179]
    v_mfma_f32_16x16x32_bf16 v[180:183], v[204:207], v[224:227], v[180:183]
    v_mfma_f32_16x16x32_bf16 v[184:187], v[204:207], v[228:231], v[184:187]
    s_waitcnt lgkmcnt(0)
    s_barrier
    ds_read_b64_tr_b16 v[200:201], v16 offset:49152
    ds_read_b64_tr_b16 v[202:203], v16 offset:50176
    ds_read_b128 v[208:211], v14 offset:256
    ds_read_b128 v[212:215], v14 offset:8448
    ds_read_b128 v[216:219], v14 offset:16640
    ds_read_b64_tr_b16 v[204:205], v16 offset:57344
    ds_read_b64_tr_b16 v[206:207], v16 offset:58368
    ds_read_b128 v[220:223], v15 offset:256
    ds_read_b128 v[224:227], v15 offset:8448
    ds_read_b128 v[228:231], v15 offset:16640
    v_mfma_f32_16x16x32_bf16 v[176:179], v[32:35], v[40:43], v[176:179]
    v_mfma_f32_16x16x32_bf16 v[180:183], v[32:35], v[44:47], v[180:183]
    v_mfma_f32_16x16x32_bf16 v[184:187], v[32:35], v[48:51], v[184:187]
    v_mfma_f32_16x16x32_bf16 v[176:179], v[36:39], v[52:55], v[176:179]
    v_mfma_f32_16x16x32_bf16 v[180:183], v[36:39], v[56:59], v[180:183]
    v_mfma_f32_16x16x32_bf16 v[184:187], v[36:39], v[60:63], v[184:187]
    s_waitcnt lgkmcnt(0)
    s_barrier
    v_add_u32 v12, 24576, v12
    v_add_u32 v13, 24576, v13
    v_add_u32 v14, 24576, v14
    v_add_u32 v15, 24576, v15
    ds_read_b64_tr_b16 v[32:33], v16 offset:0
    ds_read_b64_tr_b16 v[34:35], v16 offset:1024
    ds_read_b128 v[40:43], v12 offset:0
    ds_read_b128 v[44:47], v12 offset:8192
    ds_read_b128 v[48:51], v12 offset:16384
    ds_read_b64_tr_b16 v[36:37], v16 offset:8192
    ds_read_b64_tr_b16 v[38:39], v16 offset:9216
    ds_read_b128 v[52:55], v13 offset:0
    ds_read_b128 v[56:59], v13 offset:8192
    ds_read_b128 v[60:63], v13 offset:16384
    v_mfma_f32_16x16x32_bf16 v[176:179], v[200:203], v[208:211], v[176:179]
    v_mfma_f32_16x16x32_bf16 v[180:183], v[200:203], v[212:215], v[180:183]
    v_mfma_f32_16x16x32_bf16 v[184:187], v[200:203], v[216:219], v[184:187]
    v_mfma_f32_16x16x32_bf16 v[176:179], v[204:207], v[220:223], v[176:179]
    v_mfma_f32_16x16x32_bf16 v[180:183], v[204:207], v[224:227], v[180:183]
    v_mfma_f32_16x16x32_bf16 v[184:187], v[204:207], v[228:231], v[184:187]
    s_cmp_lg_u32 s21, 1
    s_cbranch_scc1 L_st5
    buffer_load_dword v1, v7, s[48:51], s41 offen
    buffer_load_dword v1, v7, s[52:55], s41 offen
L_st5:
    s_waitcnt lgkmcnt(0)
    s_barrier
    ds_read_b64_tr_b16 v[200:201], v16 offset:16384
    ds_read_b64_tr_b16 v[202:203], v16 offset:17408
    ds_read_b128 v[208:211], v14 offset:0
    ds_read_b128 v[212:215], v14 offset:8192
    ds_read_b128 v[216:219], v14 offset:16384
    ds_read_b64_tr_b16 v[204:205], v16 offset:24576
    ds_read_b64_tr_b16 v[206:207], v16 offset:25600
    ds_read_b128 v[220:223], v15 offset:0
    ds_read_b128 v[224:227], v15 offset:8192
    ds_read_b128 v[228:231], v15 offset:16384
    v_mfma_f32_16x16x32_bf16 v[176:179], v[32:35], v[40:43], v[176:179]
    v_mfma_f32_16x16x32_bf16 v[180:183], v[32:35], v[44:47], v[180:183]
    v_mfma_f32_16x16x32_bf16 v[184:187], v[32:35], v[48:51], v[184:187]
    v_mfma_f32_16x16x32_bf16 v[176:179], v[36:39], v[52:55], v[176:179]
    v_mfma_f32_16x16x32_bf16 v[180:183], v[36:39], v[56:59], v[180:183]
    v_mfma_f32_16x16x32_bf16 v[184:187], v[36:39], v[60:63], v[184:187]
    s_waitcnt lgkmcnt(0)
    s_barrier
    ds_read_b64_tr_b16 v[32:33], v16 offset:32768
    ds_read_b64_tr_b16 v[34:35], v16 offset:33792
    ds_read_b128 v[40:43], v12 offset:256
    ds_read_b128 v[44:47], v12 offset:8448
    ds_read_b128 v[48:51], v12 offset:16640
    ds_read_b64_tr_b16 v[36:37], v16 offset:40960
    ds_read_b64_tr_b16 v[38:39], v16 offset:41984
    ds_read_b128 v[52:55], v13 offset:256
    ds_read_b128 v[56:59], v13 offset:8448
    ds_read_b128 v[60:63], v13 offset:16640
    v_mfma_f32_16x16x32_bf16 v[176:179], v[200:203], v[208:211], v[176:179]
    v_mfma_f32_16x16x32_bf16 v[180:183], v[200:203], v[212:215], v[180:183]
    v_mfma_f32_16x16x32_bf16 v[184:187], v[200:203], v[216:219], v[184:187]
    v_mfma_f32_16x16x32_bf16 v[176:179], v[204:207], v[220:223], v[176:179]
    v_mfma_f32_16x16x32_bf16 v[180:183], v[204:207], v[224:227], v[180:183]
    v_mfma_f32_16x16x32_bf16 v[184:187], v[204:207], v[228:231], v[184:187]
    s_waitcnt lgkmcnt(0)
    s_barrier
    ds_read_b64_tr_b16 v[200:201], v16 offset:49152
    ds_read_b64_tr_b16 v[202:203], v16 offset:50176
    ds_read_b128 v[208:211], v14 offset:256
    ds_read_b128 v[212:215], v14 offset:8448
    ds_read_b128 v[216:219], v14 offset:16640
    ds_read_b64_tr_b16 v[204:205], v16 offset:57344
    ds_read_b64_tr_b16 v[206:207], v16 offset:58368
    ds_read_b128 v[220:223], v15 offset:256
    ds_read_b128 v[224:227], v15 offset:8448
    ds_read_b128 v[228:231], v15 offset:16640
    v_mfma_f32_16x16x32_bf16 v[176:179], v[32:35], v[40:43], v[176:179]
    v_mfma_f32_16x16x32_bf16 v[180:183], v[32:35], v[44:47], v[180:183]
    v_mfma_f32_16x16x32_bf16 v[184:187], v[32:35], v[48:51], v[184:187]
    v_mfma_f32_16x16x32_bf16 v[176:179], v[36:39], v[52:55], v[176:179]
    v_mfma_f32_16x16x32_bf16 v[180:183], v[36:39], v[56:59], v[180:183]
    v_mfma_f32_16x16x32_bf16 v[184:187], v[36:39], v[60:63], v[184:187]
    s_waitcnt lgkmcnt(0)
    s_barrier
    v_add_u32 v12, 24576, v12
    v_add_u32 v13, 24576, v13
    v_add_u32 v14, 24576, v14
    v_add_u32 v15, 24576, v15
    ds_read_b64_tr_b16 v[32:33], v16 offset:0
    ds_read_b64_tr_b16 v[34:35], v16 offset:1024
    ds_read_b128 v[40:43], v12 offset:0
    ds_read_b128 v[44:47], v12 offset:8192
    ds_read_b128 v[48:51], v12 offset:16384
    ds_read_b64_tr_b16 v[36:37], v16 offset:8192
    ds_read_b64_tr_b16 v[38:39], v16 offset:9216
    ds_read_b128 v[52:55], v13 offset:0
    ds_read_b128 v[56:59], v13 offset:8192
    ds_read_b128 v[60:63], v13 offset:16384
    v_mfma_f32_16x16x32_bf16 v[176:179], v[200:203], v[208:211], v[176:179]
    v_mfma_f32_16x16x32_bf16 v[180:183], v[200:203], v[212:215], v[180:183]
    v_mfma_f32_16x16x32_bf16 v[184:187], v[200:203], v[216:219], v[184:187]
    v_mfma_f32_16x16x32_bf16 v[176:179], v[204:207], v[220:223], v[176:179]
    v_mfma_f32_16x16x32_bf16 v[180:183], v[204:207], v[224:227], v[180:183]
    v_mfma_f32_16x16x32_bf16 v[184:187], v[204:207], v[228:231], v[184:187]
    s_cmp_lg_u32 s21, 2
    s_cbranch_scc1 L_st6
    buffer_load_dword v1, v7, s[48:51], s41 offen
    buffer_load_dword v1, v7, s[52:55], s41 offen
L_st6:
    s_add_u32 m0, s28, 65536
    s_add_u32 s30, s25, 0
    buffer_load_dwordx4 v2, s[48:51], s30 offen offset:0 lds
    buffer_load_dwordx4 v3, s[48:51], s30 offen offset:1024 lds
    buffer_load_dwordx4 v2, s[48:51], s30 offen offset:2048 lds
    buffer_load_dwordx4 v3, s[48:51], s30 offen offset:3072 lds
    s_waitcnt lgkmcnt(0)
    s_barrier
    ds_read_b64_tr_b16 v[200:201], v16 offset:16384
    ds_read_b64_tr_b16 v[202:203], v16 offset:17408
    ds_read_b128 v[208:211], v14 offset:0
    ds_read_b128 v[212:215], v14 offset:8192
    ds_read_b128 v[216:219], v14 offset:16384
    ds_read_b64_tr_b16 v[204:205], v16 offset:24576
    ds_read_b64_tr_b16 v[206:207], v16 offset:25600
    ds_read_b128 v[220:223], v15 offset:0
    ds_read_b128 v[224:227], v15 offset:8192
    ds_read_b128 v[228:231], v15 offset:16384
    v_mfma_f32_16x16x32_bf16 v[176:179], v[32:35], v[40:43], v[176:179]
    v_mfma_f32_16x16x32_bf16 v[180:183], v[32:35], v[44:47], v[180:183]
    v_mfma_f32_16x16x32_bf16 v[184:187], v[32:35], v[48:51], v[184:187]
    v_mfma_f32_16x16x32_bf16 v[176:179], v[36:39], v[52:55], v[176:179]
    v_mfma_f32_16x16x32_bf16 v[180:183], v[36:39], v[56:59], v[180:183]
    v_mfma_f32_16x16x32_bf16 v[184:187], v[36:39], v[60:63], v[184:187]
    s_add_u32 m0, s28, 98304
    s_add_u32 s30, s25, 4096
    buffer_load_dwordx4 v2, s[48:51], s30 offen offset:0 lds
    buffer_load_dwordx4 v3, s[48:51], s30 offen offset:1024 lds
    buffer_load_dwordx4 v2, s[48:51], s30 offen offset:2048 lds
    buffer_load_dwordx4 v3, s[48:51], s30 offen offset:3072 lds
    s_waitcnt lgkmcnt(0)
    s_barrier
    ds_read_b64_tr_b16 v[32:33], v16 offset:32768
    ds_read_b64_tr_b16 v[34:35], v16 offset:33792
    ds_read_b128 v[40:43], v12 offset:256
    ds_read_b128 v[44:47], v12 offset:8448
    ds_read_b128 v[48:51], v12 offset:16640
    ds_read_b64_tr_b16 v[36:37], v16 offset:40960
    ds_read_b64_tr_b16 v[38:39], v16 offset:41984
    ds_read_b128 v[52:55], v13 offset:256
    ds_read_b128 v[56:59], v13 offset:8448
    ds_read_b128 v[60:63], v13 offset:16640
    v_mfma_f32_16x16x32_bf16 v[176:179], v[200:203], v[208:211], v[176:179]
    v_mfma_f32_16x16x32_bf16 v[180:183], v[200:203], v[212:215], v[180:183]
    v_mfma_f32_16x16x32_bf16 v[184:187], v[200:203], v[216:219], v[184:187]
    v_mfma_f32_16x16x32_bf16 v[176:179], v[204:207], v[220:223], v[176:179]
    v_mfma_f32_16x16x32_bf16 v[180:183], v[204:207], v[224:227], v[180:183]
    v_mfma_f32_16x16x32_bf16 v[184:187], v[204:207], v[228:231], v[184:187]
    s_add_u32 m0, s28, 0
    s_add_u32 s30, s25, 0
    buffer_load_dwordx4 v2, s[52:55], s30 offen offset:0 lds
    buffer_load_dwordx4 v3, s[52:55], s30 offen offset:1024 lds
    buffer_load_dwordx4 v2, s[52:55], s30 offen offset:2048 lds
    buffer_load_dwordx4 v3, s[52:55], s30 offen offset:3072 lds
    s_waitcnt lgkmcnt(0)
    s_barrier
    ds_read_b64_tr_b16 v[200:201], v16 offset:49152
    ds_read_b64_tr_b16 v[202:203], v16 offset:50176
    ds_read_b128 v[208:211], v14 offset:256
    ds_read_b128 v[212:215], v14 offset:8448
    ds_read_b128 v[216:219], v14 offset:16640
    ds_read_b64_tr_b16 v[204:205], v16 offset:57344
    ds_read_b64_tr_b16 v[206:207], v16 offset:58368
    ds_read_b128 v[220:223], v15 offset:256
    ds_read_b128 v[224:227], v15 offset:8448
    ds_read_b128 v[228:231], v15 offset:16640
    v_mfma_f32_16x16x32_bf16 v[176:179], v[32:35], v[40:43], v[176:179]
    v_mfma_f32_16x16x32_bf16 v[180:183], v[32:35], v[44:47], v[180:183]
    v_mfma_f32_16x16x32_bf16 v[184:187], v[32:35], v[48:51], v[184:187]
    v_mfma_f32_16x16x32_bf16 v[176:179], v[36:39], v[52:55], v[176:179]
    v_mfma_f32_16x16x32_bf16 v[180:183], v[36:39], v[56:59], v[180:183]
    v_mfma_f32_16x16x32_bf16 v[184:187], v[36:39], v[60:63], v[184:187]
    s_waitcnt lgkmcnt(0)
    v_mfma_f32_16x16x32_bf16 v[176:179], v[200:203], v[208:211], v[176:179]
    v_mfma_f32_16x16x32_bf16 v[180:183], v[200:203], v[212:215], v[180:183]
    v_mfma_f32_16x16x32_bf16 v[184:187], v[200:203], v[216:219], v[184:187]
    v_mfma_f32_16x16x32_bf16 v[176:179], v[204:207], v[220:223], v[176:179]
    v_mfma_f32_16x16x32_bf16 v[180:183], v[204:207], v[224:227], v[180:183]
    v_mfma_f32_16x16x32_bf16 v[184:187], v[204:207], v[228:231], v[184:187]
L_qdone:
    v_lshrrev_b32 v24, 4, v0
    v_and_b32 v26, 15, v0
    v_lshrrev_b32 v25, 1, v24
    s_lshl_b32 s29, s3, 1
    v_add_u32 v25, s29, v25
    v_and_b32 v27, 7, v0
    v_lshlrev_b32 v27, 1, v27
    v_xor_b32 v25, v25, v27
    v_lshlrev_b32 v25, 4, v25
    v_lshl_add_u32 v25, v26, 9, v25
    v_and_b32 v27, 1, v24
    v_lshl_add_u32 v25, v27, 3, v25
    v_add_u32 v25, 139264, v25
    s_mov_b32 s29, 1040356334
    v_mul_f32 v176, s29, v176
    v_mul_f32 v177, s29, v177
    v_mul_f32 v178, s29, v178
    v_mul_f32 v179, s29, v179
    v_mul_f32 v180, s29, v180
    v_mul_f32 v181, s29, v181
    v_mul_f32 v182, s29, v182
    v_mul_f32 v183, s29, v183
    v_mul_f32 v184, s29, v184
    v_mul_f32 v185, s29, v185
    v_mul_f32 v186, s29, v186
    v_mul_f32 v187, s29, v187
    v_cvt_pk_bf16_f32 v176, v176, v177
    v_cvt_pk_bf16_f32 v177, v178, v179
    ds_write_b64 v25, v[176:177] offset:0
    v_cvt_pk_bf16_f32 v180, v180, v181
    v_cvt_pk_bf16_f32 v181, v182, v183
    ds_write_b64 v25, v[180:181] offset:8192
    v_cvt_pk_bf16_f32 v184, v184, v185
    v_cvt_pk_bf16_f32 v185, v186, v187
    ds_write_b64 v25, v[184:185] offset:16384
    v_lshrrev_b32 v24, 2, v0
    v_and_b32 v26, 7, v24
    v_lshlrev_b32 v26, 5, v26
    v_lshl_add_u32 v26, v24, 8, v26
    v_and_b32 v27, 3, v0
    v_lshl_add_u32 v26, v27, 3, v26
    v_add_u32 v26, s28, v26
    v_add_u32 v28, 65536, v8
    v_add_u32 v29, 65536, v9
    v_add_u32 v30, 65536, v10
    v_add_u32 v31, 65536, v11
    s_waitcnt lgkmcnt(0)
    s_barrier
    ds_read_b128 v[32:35], v12 offset:0
    ds_read_b128 v[36:39], v12 offset:8192
    ds_read_b128 v[40:43], v12 offset:16384
    ds_read_b128 v[44:47], v13 offset:0
    ds_read_b128 v[48:51], v13 offset:8192
    ds_read_b128 v[52:55], v13 offset:16384
    ds_read_b128 v[56:59], v14 offset:0
    ds_read_b128 v[60:63], v14 offset:8192
    ds_read_b128 v[64:67], v14 offset:16384
    ds_read_b128 v[68:71], v15 offset:0
    ds_read_b128 v[72:75], v15 offset:8192
    ds_read_b128 v[76:79], v15 offset:16384
    s_add_u32 m0, s28, 32768
    s_add_u32 s30, s25, 4096
    buffer_load_dwordx4 v2, s[52:55], s30 offen offset:0 lds
    buffer_load_dwordx4 v3, s[52:55], s30 offen offset:1024 lds
    buffer_load_dwordx4 v2, s[52:55], s30 offen offset:2048 lds
    buffer_load_dwordx4 v3, s[52:55], s30 offen offset:3072 lds
    v_xor_b32 v12, 0, v26
    v_xor_b32 v13, 32, v26
    v_xor_b32 v14, 64, v26
    v_xor_b32 v15, 96, v26
    v_xor_b32 v16, 128, v26
    v_xor_b32 v17, 160, v26
    v_xor_b32 v18, 192, v26
    v_xor_b32 v19, 224, v26
    s_waitcnt lgkmcnt(0)
    s_barrier
    s_add_u32 m0, s28, 131072
    s_add_u32 s30, s25, 8192
    buffer_load_dwordx4 v2, s[48:51], s30 offen offset:0 lds
    buffer_load_dwordx4 v3, s[48:51], s30 offen offset:1024 lds
    buffer_load_dwordx4 v2, s[48:51], s30 offen offset:2048 lds
    buffer_load_dwordx4 v3, s[48:51], s30 offen offset:3072 lds
    s_cmp_lg_u32 s21, 3
    s_cbranch_scc1 L_st7
    buffer_load_dword v1, v7, s[48:51], s41 offen
    buffer_load_dword v1, v7, s[52:55], s41 offen
L_st7:
    s_cmp_ge_u32 s3, 4
    s_cbranch_scc1 L_np
    s_setprio 2
L_np:
    s_waitcnt vmcnt(12)
    ds_read_b128 v[200:203], v8 offset:0
    ds_read_b128 v[216:219], v8 offset:32768
    ds_read_b128 v[204:207], v9 offset:0
    ds_read_b128 v[220:223], v9 offset:32768
    ds_read_b128 v[208:211], v10 offset:0
    ds_read_b128 v[224:227], v10 offset:32768
    ds_read_b128 v[212:215], v11 offset:0
    ds_read_b128 v[228:231], v11 offset:32768
    s_mov_b32 s36, 0
    s_waitcnt lgkmcnt(6)
    v_mfma_f32_16x16x32_bf16 v[232:235], v[200:203], v[32:35], 0
    v_mfma_f32_16x16x32_bf16 v[236:239], v[216:219], v[32:35], 0
    s_waitcnt lgkmcnt(4)
    v_mfma_f32_16x16x32_bf16 v[232:235], v[204:207], v[44:47], v[232:235]
    v_mfma_f32_16x16x32_bf16 v[236:239], v[220:223], v[44:47], v[236:239]
    s_waitcnt lgkmcnt(2)
    v_mfma_f32_16x16x32_bf16 v[232:235], v[208:211], v[56:59], v[232:235]
    v_mfma_f32_16x16x32_bf16 v[236:239], v[224:227], v[56:59], v[236:239]
    s_waitcnt lgkmcnt(0)
    v_mfma_f32_16x16x32_bf16 v[232:235], v[212:215], v[68:71], v[232:235]
    v_mfma_f32_16x16x32_bf16 v[236:239], v[228:231], v[68:71], v[236:239]
    v_mfma_f32_16x16x32_bf16 v[240:243], v[200:203], v[36:39], 0
    s_add_u32 m0, s28, 65536
    s_add_u32 s30, s25, 12288
    buffer_load_dwordx4 v2, s[48:51], s30 offen offset:0 lds
    v_mfma_f32_16x16x32_bf16 v[244:247], v[216:219], v[36:39], 0
    v_mfma_f32_16x16x32_bf16 v[240:243], v[204:207], v[48:51], v[240:243]
    buffer_load_dwordx4 v3, s[48:51], s30 offen offset:1024 lds
    v_max3_f32 v24, v232, v233, v234
    v_max3_f32 v25, v235, v236, v237
    v_max3_f32 v24, v24, v238, v239
    v_max_f32 v24, v24, v25
    v_mov_b32 v25, v24
    s_nop 1
    v_mfma_f32_16x16x32_bf16 v[244:247], v[220:223], v[48:51], v[244:247]
    v_permlane32_swap_b32 v24, v25
    s_nop 1
    v_max_f32 v24, v24, v25
    v_mov_b32 v25, v24
    s_nop 1
    v_permlane16_swap_b32 v24, v25
    v_mfma_f32_16x16x32_bf16 v[240:243], v[208:211], v[60:63], v[240:243]
    buffer_load_dwordx4 v2, s[48:51], s30 offen offset:2048 lds
    s_nop 1
    v_max_f32 v24, v24, v25
    v_sub_f32 v232, v232, v24
    v_sub_f32 v233, v233, v24
    v_sub_f32 v234, v234, v24
    v_sub_f32 v235, v235, v24
    v_sub_f32 v236, v236, v24
    v_mfma_f32_16x16x32_bf16 v[244:247], v[224:227], v[60:63], v[244:247]
    v_sub_f32 v237, v237, v24
    v_sub_f32 v238, v238, v24
    v_sub_f32 v239, v239, v24
    v_sub_f32 v188, 0, v24
    v_sub_f32 v189, 0, v24
    v_sub_f32 v190, 0, v24
    v_mfma_f32_16x16x32_bf16 v[240:243], v[212:215], v[72:75], v[240:243]
    buffer_load_dwordx4 v3, s[48:51], s30 offen offset:3072 lds
    v_sub_f32 v191, 0, v24
    v_exp_f32 v232, v232
    v_exp_f32 v233, v233
    v_exp_f32 v234, v234
    v_exp_f32 v235, v235
    v_exp_f32 v236, v236
    v_mfma_f32_16x16x32_bf16 v[244:247], v[228:231], v[72:75], v[244:247]
    v_exp_f32 v237, v237
    v_exp_f32 v238, v238
    v_exp_f32 v239, v239
    v_cvt_pk_bf16_f32 v232, v232, v233
    v_cvt_pk_bf16_f32 v233, v234, v235
    v_cvt_pk_bf16_f32 v234, v236, v237
    v_cvt_pk_bf16_f32 v235, v238, v239
    v_mfma_f32_16x16x32_bf16 v[248:251], v[200:203], v[40:43], 0
    s_add_u32 m0, s28, 98304
    s_add_u32 s30, s25, 16384
    buffer_load_dwordx4 v2, s[48:51], s30 offen offset:0 lds
    v_mfma_f32_16x16x32_bf16 v[252:255], v[216:219], v[40:43], 0
    v_mfma_f32_16x16x32_bf16 v[248:251], v[204:207], v[52:55], v[248:251]
    buffer_load_dwordx4 v3, s[48:51], s30 offen offset:1024 lds
    v_max3_f32 v24, v240, v241, v242
    v_max3_f32 v25, v243, v244, v245
    v_max3_f32 v24, v24, v246, v247
    v_max_f32 v24, v24, v25
    v_mov_b32 v25, v24
    s_nop 1
    v_mfma_f32_16x16x32_bf16 v[252:255], v[220:223], v[52:55], v[252:255]
    v_permlane32_swap_b32 v24, v25
    s_nop 1
    v_max_f32 v24, v24, v25
    v_mov_b32 v25, v24
    s_nop 1
    v_permlane16_swap_b32 v24, v25
    v_mfma_f32_16x16x32_bf16 v[248:251], v[208:211], v[64:67], v[248:251]
    buffer_load_dwordx4 v2, s[48:51], s30 offen offset:2048 lds
    s_nop 1
    v_max_f32 v24, v24, v25
    v_sub_f32 v240, v240, v24
    v_sub_f32 v241, v241, v24
    v_sub_f32 v242, v242, v24
    v_sub_f32 v243, v243, v24
    v_sub_f32 v244, v244, v24
    v_mfma_f32_16x16x32_bf16 v[252:255], v[224:227], v[64:67], v[252:255]
    v_sub_f32 v245, v245, v24
    v_sub_f32 v246, v246, v24
    v_sub_f32 v247, v247, v24
    v_sub_f32 v192, 0, v24
    v_sub_f32 v193, 0, v24
    v_sub_f32 v194, 0, v24
    v_mfma_f32_16x16x32_bf16 v[248:251], v[212:215], v[76:79], v[248:251]
    buffer_load_dwordx4 v3, s[48:51], s30 offen offset:3072 lds
    v_sub_f32 v195, 0, v24
    v_exp_f32 v240, v240
    v_exp_f32 v241, v241
    v_exp_f32 v242, v242
    v_exp_f32 v243, v243
    v_exp_f32 v244, v244
    v_mfma_f32_16x16x32_bf16 v[252:255], v[228:231], v[76:79], v[252:255]
    v_exp_f32 v245, v245
    v_exp_f32 v246, v246
    v_exp_f32 v247, v247
    v_cvt_pk_bf16_f32 v240, v240, v241
    v_cvt_pk_bf16_f32 v241, v242, v243
    v_cvt_pk_bf16_f32 v242, v244, v245
    v_cvt_pk_bf16_f32 v243, v246, v247
    s_waitcnt vmcnt(12)
    ds_read_b64_tr_b16 v[200:201], v12 offset:0
    ds_read_b64_tr_b16 v[202:203], v12 offset:32768
    ds_read_b64_tr_b16 v[204:205], v13 offset:0
    ds_read_b64_tr_b16 v[206:207], v13 offset:32768
    ds_read_b64_tr_b16 v[208:209], v14 offset:0
    ds_read_b64_tr_b16 v[210:211], v14 offset:32768
    ds_read_b64_tr_b16 v[212:213], v15 offset:0
    ds_read_b64_tr_b16 v[214:215], v15 offset:32768
    ds_read_b64_tr_b16 v[216:217], v16 offset:0
    ds_read_b64_tr_b16 v[218:219], v16 offset:32768
    ds_read_b64_tr_b16 v[220:221], v17 offset:0
    ds_read_b64_tr_b16 v[222:223], v17 offset:32768
    ds_read_b64_tr_b16 v[224:225], v18 offset:0
    ds_read_b64_tr_b16 v[226:227], v18 offset:32768
    ds_read_b64_tr_b16 v[228:229], v19 offset:0
    ds_read_b64_tr_b16 v[230:231], v19 offset:32768
    v_mfma_f32_16x16x32_bf16 v[176:179], v[20:23], v[232:235], 0
    v_mfma_f32_16x16x32_bf16 v[180:183], v[20:23], v[240:243], 0
    v_max3_f32 v24, v248, v249, v250
    v_max3_f32 v25, v251, v252, v253
    v_max3_f32 v24, v24, v254, v255
    v_max_f32 v24, v24, v25
    v_mov_b32 v25, v24
    s_nop 1
    v_permlane32_swap_b32 v24, v25
    s_nop 1
    v_max_f32 v24, v24, v25
    v_mov_b32 v25, v24
    s_nop 1
    v_permlane16_swap_b32 v24, v25
    s_nop 1
    v_max_f32 v24, v24, v25
    v_sub_f32 v248, v248, v24
    v_sub_f32 v249, v249, v24
    v_sub_f32 v250, v250, v24
    v_sub_f32 v251, v251, v24
    v_sub_f32 v252, v252, v24
    v_sub_f32 v253, v253, v24
    v_sub_f32 v254, v254, v24
    v_sub_f32 v255, v255, v24
    v_sub_f32 v196, 0, v24
    v_sub_f32 v197, 0, v24
    v_sub_f32 v198, 0, v24
    v_sub_f32 v199, 0, v24
    v_exp_f32 v248, v248
    v_exp_f32 v249, v249
    v_exp_f32 v250, v250
    v_exp_f32 v251, v251
    v_exp_f32 v252, v252
    v_exp_f32 v253, v253
    v_exp_f32 v254, v254
    v_exp_f32 v255, v255
    v_cvt_pk_bf16_f32 v248, v248, v249
    v_cvt_pk_bf16_f32 v249, v250, v251
    v_cvt_pk_bf16_f32 v250, v252, v253
    v_cvt_pk_bf16_f32 v251, v254, v255
    s_waitcnt lgkmcnt(12)
    v_mfma_f32_16x16x32_bf16 v[80:83], v[200:203], v[232:235], 0
    v_mfma_f32_16x16x32_bf16 v[92:95], v[204:207], v[232:235], 0
    s_waitcnt lgkmcnt(8)
    v_mfma_f32_16x16x32_bf16 v[104:107], v[208:211], v[232:235], 0
    v_mfma_f32_16x16x32_bf16 v[116:119], v[212:215], v[232:235], 0
    s_waitcnt lgkmcnt(4)
    v_mfma_f32_16x16x32_bf16 v[128:131], v[216:219], v[232:235], 0
    v_mfma_f32_16x16x32_bf16 v[140:143], v[220:223], v[232:235], 0
    s_waitcnt lgkmcnt(0)
    v_mfma_f32_16x16x32_bf16 v[152:155], v[224:227], v[232:235], 0
    v_mfma_f32_16x16x32_bf16 v[164:167], v[228:231], v[232:235], 0
    v_mfma_f32_16x16x32_bf16 v[84:87], v[200:203], v[240:243], 0
    s_add_u32 m0, s28, 0
    s_add_u32 s30, s25, 8192
    buffer_load_dwordx4 v2, s[52:55], s30 offen offset:0 lds
    v_mfma_f32_16x16x32_bf16 v[96:99], v[204:207], v[240:243], 0
    buffer_load_dwordx4 v3, s[52:55], s30 offen offset:1024 lds
    v_mfma_f32_16x16x32_bf16 v[108:111], v[208:211], v[240:243], 0
    buffer_load_dwordx4 v2, s[52:55], s30 offen offset:2048 lds
    v_mfma_f32_16x16x32_bf16 v[120:123], v[212:215], v[240:243], 0
    buffer_load_dwordx4 v3, s[52:55], s30 offen offset:3072 lds
    v_mfma_f32_16x16x32_bf16 v[132:135], v[216:219], v[240:243], 0
    s_add_u32 m0, s28, 32768
    s_add_u32 s30, s25, 12288
    buffer_load_dwordx4 v2, s[52:55], s30 offen offset:0 lds
    v_mfma_f32_16x16x32_bf16 v[144:147], v[220:223], v[240:243], 0
    buffer_load_dwordx4 v3, s[52:55], s30 offen offset:1024 lds
    v_mfma_f32_16x16x32_bf16 v[156:159], v[224:227], v[240:243], 0
    buffer_load_dwordx4 v2, s[52:55], s30 offen offset:2048 lds
    v_mfma_f32_16x16x32_bf16 v[168:171], v[228:231], v[240:243], 0
    buffer_load_dwordx4 v3, s[52:55], s30 offen offset:3072 lds
    v_mfma_f32_16x16x32_bf16 v[184:187], v[20:23], v[248:251], 0
    v_mfma_f32_16x16x32_bf16 v[88:91], v[200:203], v[248:251], 0
    v_mfma_f32_16x16x32_bf16 v[100:103], v[204:207], v[248:251], 0
    v_mfma_f32_16x16x32_bf16 v[112:115], v[208:211], v[248:251], 0
    v_mfma_f32_16x16x32_bf16 v[124:127], v[212:215], v[248:251], 0
    v_mfma_f32_16x16x32_bf16 v[136:139], v[216:219], v[248:251], 0
    v_mfma_f32_16x16x32_bf16 v[148:151], v[220:223], v[248:251], 0
    v_mfma_f32_16x16x32_bf16 v[160:163], v[224:227], v[248:251], 0
    v_mfma_f32_16x16x32_bf16 v[172:175], v[228:231], v[248:251], 0
    s_cmp_lg_u32 s21, 4
    s_cbranch_scc1 L_st8
    buffer_load_dword v1, v7, s[48:51], s41 offen
    buffer_load_dword v1, v7, s[52:55], s41 offen
L_st8:
    s_waitcnt vmcnt(12)
    ds_read_b128 v[200:203], v28
    ds_read_b128 v[216:219], v8 offset:0
    ds_read_b128 v[204:207], v29
    ds_read_b128 v[220:223], v9 offset:0
    ds_read_b128 v[208:211], v30
    ds_read_b128 v[224:227], v10 offset:0
    ds_read_b128 v[212:215], v31
    ds_read_b128 v[228:231], v11 offset:0
    s_mov_b32 s36, 1
    s_waitcnt lgkmcnt(6)
    v_mfma_f32_16x16x32_bf16 v[232:235], v[200:203], v[32:35], v[188:191]
    v_mfma_f32_16x16x32_bf16 v[236:239], v[216:219], v[32:35], v[188:191]
    s_waitcnt lgkmcnt(4)
    v_mfma_f32_16x16x32_bf16 v[232:235], v[204:207], v[44:47], v[232:235]
    v_mfma_f32_16x16x32_bf16 v[236:239], v[220:223], v[44:47], v[236:239]
    s_waitcnt lgkmcnt(2)
    v_mfma_f32_16x16x32_bf16 v[232:235], v[208:211], v[56:59], v[232:235]
    v_mfma_f32_16x16x32_bf16 v[236:239], v[224:227], v[56:59], v[236:239]
    s_waitcnt lgkmcnt(0)
    v_mfma_f32_16x16x32_bf16 v[232:235], v[212:215], v[68:71], v[232:235]
    v_mfma_f32_16x16x32_bf16 v[236:239], v[228:231], v[68:71], v[236:239]
    v_mfma_f32_16x16x32_bf16 v[240:243], v[200:203], v[36:39], v[192:195]
    s_add_u32 m0, s28, 131072
    s_add_u32 s30, s25, 20480
    buffer_load_dwordx4 v2, s[48:51], s30 offen offset:0 lds
    v_mfma_f32_16x16x32_bf16 v[244:247], v[216:219], v[36:39], v[192:195]
    v_mfma_f32_16x16x32_bf16 v[240:243], v[204:207], v[48:51], v[240:243]
    buffer_load_dwordx4 v3, s[48:51], s30 offen offset:1024 lds
    v_max3_f32 v24, v232, v233, v234
    v_max3_f32 v25, v236, v237, v238
    v_max3_f32 v24, v24, v235, v239
    v_mfma_f32_16x16x32_bf16 v[244:247], v[220:223], v[48:51], v[244:247]
    v_max_f32 v24, v24, v25
    v_cmp_lt_f32 vcc, 0x41000000, v24
    s_cbranch_vccnz L_rare0
L_back1_0:
    v_mfma_f32_16x16x32_bf16 v[240:243], v[208:211], v[60:63], v[240:243]
    buffer_load_dwordx4 v2, s[48:51], s30 offen offset:2048 lds
    v_exp_f32 v232, v232
    v_exp_f32 v233, v233
    v_exp_f32 v234, v234
    v_mfma_f32_16x16x32_bf16 v[244:247], v[224:227], v[60:63], v[244:247]
    v_exp_f32 v235, v235
    v_exp_f32 v236, v236
    v_exp_f32 v237, v237
    v_mfma_f32_16x16x32_bf16 v[240:243], v[212:215], v[72:75], v[240:243]
    buffer_load_dwordx4 v3, s[48:51], s30 offen offset:3072 lds
    v_exp_f32 v238, v238
    v_exp_f32 v239, v239
    v_cvt_pk_bf16_f32 v232, v232, v233
    v_mfma_f32_16x16x32_bf16 v[244:247], v[228:231], v[72:75], v[244:247]
    v_cvt_pk_bf16_f32 v233, v234, v235
    v_cvt_pk_bf16_f32 v234, v236, v237
    v_cvt_pk_bf16_f32 v235, v238, v239
    v_mfma_f32_16x16x32_bf16 v[248:251], v[200:203], v[40:43], v[196:199]
    s_add_u32 m0, s28, 65536
    s_add_u32 s30, s25, 24576
    buffer_load_dwordx4 v2, s[48:51], s30 offen offset:0 lds
    v_mfma_f32_16x16x32_bf16 v[252:255], v[216:219], v[40:43], v[196:199]
    v_mfma_f32_16x16x32_bf16 v[248:251], v[204:207], v[52:55], v[248:251]
    buffer_load_dwordx4 v3, s[48:51], s30 offen offset:1024 lds
    v_max3_f32 v24, v240, v241, v242
    v_max3_f32 v25, v244, v245, v246
    v_max3_f32 v24, v24, v243, v247
    v_mfma_f32_16x16x32_bf16 v[252:255], v[220:223], v[52:55], v[252:255]
    v_max_f32 v24, v24, v25
    v_cmp_lt_f32 vcc, 0x41000000, v24
    s_cbranch_vccnz L_rare1
L_back1_1:
    v_mfma_f32_16x16x32_bf16 v[248:251], v[208:211], v[64:67], v[248:251]
    buffer_load_dwordx4 v2, s[48:51], s30 offen offset:2048 lds
    v_exp_f32 v240, v240
    v_exp_f32 v241, v241
    v_exp_f32 v242, v242
    v_mfma_f32_16x16x32_bf16 v[252:255], v[224:227], v[64:67], v[252:255]
    v_exp_f32 v243, v243
    v_exp_f32 v244, v244
    v_exp_f32 v245, v245
    v_mfma_f32_16x16x32_bf16 v[248:251], v[212:215], v[76:79], v[248:251]
    buffer_load_dwordx4 v3, s[48:51], s30 offen offset:3072 lds
    v_exp_f32 v246, v246
    v_exp_f32 v247, v247
    v_cvt_pk_bf16_f32 v240, v240, v241
    v_mfma_f32_16x16x32_bf16 v[252:255], v[228:231], v[76:79], v[252:255]
    v_cvt_pk_bf16_f32 v241, v242, v243
    v_cvt_pk_bf16_f32 v242, v244, v245
    v_cvt_pk_bf16_f32 v243, v246, v247
    s_waitcnt vmcnt(8)
    ds_read_b64_tr_b16 v[200:201], v12 offset:0
    ds_read_b64_tr_b16 v[202:203], v12 offset:32768
    ds_read_b64_tr_b16 v[204:205], v13 offset:0
    ds_read_b64_tr_b16 v[206:207], v13 offset:32768
    ds_read_b64_tr_b16 v[208:209], v14 offset:0
    ds_read_b64_tr_b16 v[210:211], v14 offset:32768
    ds_read_b64_tr_b16 v[212:213], v15 offset:0
    ds_read_b64_tr_b16 v[214:215], v15 offset:32768
    ds_read_b64_tr_b16 v[216:217], v16 offset:0
    ds_read_b64_tr_b16 v[218:219], v16 offset:32768
    ds_read_b64_tr_b16 v[220:221], v17 offset:0
    ds_read_b64_tr_b16 v[222:223], v17 offset:32768
    ds_read_b64_tr_b16 v[224:225], v18 offset:0
    ds_read_b64_tr_b16 v[226:227], v18 offset:32768
    ds_read_b64_tr_b16 v[228:229], v19 offset:0
    ds_read_b64_tr_b16 v[230:231], v19 offset:32768
    v_mfma_f32_16x16x32_bf16 v[176:179], v[20:23], v[232:235], v[176:179]
    v_mfma_f32_16x16x32_bf16 v[180:183], v[20:23], v[240:243], v[180:183]
    v_max3_f32 v24, v248, v249, v250
    v_max3_f32 v25, v252, v253, v254
    v_max3_f32 v24, v24, v251, v255
    v_max_f32 v24, v24, v25
    v_cmp_lt_f32 vcc, 0x41000000, v24
    s_cbranch_vccnz L_rare2
L_back1_2:
    v_exp_f32 v248, v248
    v_exp_f32 v249, v249
    v_exp_f32 v250, v250
    v_exp_f32 v251, v251
    v_exp_f32 v252, v252
    v_exp_f32 v253, v253
    v_exp_f32 v254, v254
    v_exp_f32 v255, v255
    v_cvt_pk_bf16_f32 v248, v248, v249
    v_cvt_pk_bf16_f32 v249, v250, v251
    v_cvt_pk_bf16_f32 v250, v252, v253
    v_cvt_pk_bf16_f32 v251, v254, v255
    s_waitcnt lgkmcnt(12)
    v_mfma_f32_16x16x32_bf16 v[80:83], v[200:203], v[232:235], v[80:83]
    v_mfma_f32_16x16x32_bf16 v[92:95], v[204:207], v[232:235], v[92:95]
    s_waitcnt lgkmcnt(8)
    v_mfma_f32_16x16x32_bf16 v[104:107], v[208:211], v[232:235], v[104:107]
    v_mfma_f32_16x16x32_bf16 v[116:119], v[212:215], v[232:235], v[116:119]
    s_waitcnt lgkmcnt(4)
    v_mfma_f32_16x16x32_bf16 v[128:131], v[216:219], v[232:235], v[128:131]
    v_mfma_f32_16x16x32_bf16 v[140:143], v[220:223], v[232:235], v[140:143]
    s_waitcnt lgkmcnt(0)
    v_mfma_f32_16x16x32_bf16 v[152:155], v[224:227], v[232:235], v[152:155]
    v_mfma_f32_16x16x32_bf16 v[164:167], v[228:231], v[232:235], v[164:167]
    v_mfma_f32_16x16x32_bf16 v[84:87], v[200:203], v[240:243], v[84:87]
    s_add_u32 m0, s28, 0
    s_add_u32 s30, s25, 16384
    buffer_load_dwordx4 v2, s[52:55], s30 offen offset:0 lds
    v_mfma_f32_16x16x32_bf16 v[96:99], v[204:207], v[240:243], v[96:99]
    buffer_load_dwordx4 v3, s[52:55], s30 offen offset:1024 lds
    v_mfma_f32_16x16x32_bf16 v[108:111], v[208:211], v[240:243], v[108:111]
    buffer_load_dwordx4 v2, s[52:55], s30 offen offset:2048 lds
    v_mfma_f32_16x16x32_bf16 v[120:123], v[212:215], v[240:243], v[120:123]
    buffer_load_dwordx4 v3, s[52:55], s30 offen offset:3072 lds
    v_mfma_f32_16x16x32_bf16 v[132:135], v[216:219], v[240:243], v[132:135]
    s_add_u32 m0, s28, 32768
    s_add_u32 s30, s25, 20480
    buffer_load_dwordx4 v2, s[52:55], s30 offen offset:0 lds
    v_mfma_f32_16x16x32_bf16 v[144:147], v[220:223], v[240:243], v[144:147]
    buffer_load_dwordx4 v3, s[52:55], s30 offen offset:1024 lds
    v_mfma_f32_16x16x32_bf16 v[156:159], v[224:227], v[240:243], v[156:159]
    buffer_load_dwordx4 v2, s[52:55], s30 offen offset:2048 lds
    v_mfma_f32_16x16x32_bf16 v[168:171], v[228:231], v[240:243], v[168:171]
    buffer_load_dwordx4 v3, s[52:55], s30 offen offset:3072 lds
    v_mfma_f32_16x16x32_bf16 v[184:187], v[20:23], v[248:251], v[184:187]
    v_mfma_f32_16x16x32_bf16 v[88:91], v[200:203], v[248:251], v[88:91]
    v_mfma_f32_16x16x32_bf16 v[100:103], v[204:207], v[248:251], v[100:103]
    v_mfma_f32_16x16x32_bf16 v[112:115], v[208:211], v[248:251], v[112:115]
    v_mfma_f32_16x16x32_bf16 v[124:127], v[212:215], v[248:251], v[124:127]
    v_mfma_f32_16x16x32_bf16 v[136:139], v[216:219], v[248:251], v[136:139]
    v_mfma_f32_16x16x32_bf16 v[148:151], v[220:223], v[248:251], v[148:151]
    v_mfma_f32_16x16x32_bf16 v[160:163], v[224:227], v[248:251], v[160:163]
    v_mfma_f32_16x16x32_bf16 v[172:175], v[228:231], v[248:251], v[172:175]
    s_cmp_lg_u32 s21, 5
    s_cbranch_scc1 L_st9
    buffer_load_dword v1, v7, s[48:51], s41 offen
    buffer_load_dword v1, v7, s[52:55], s41 offen
L_st9:
    s_waitcnt vmcnt(12)
    ds_read_b128 v[200:203], v8 offset:32768
    ds_read_b128 v[216:219], v28
    ds_read_b128 v[204:207], v9 offset:32768
    ds_read_b128 v[220:223], v29
    ds_read_b128 v[208:211], v10 offset:32768
    ds_read_b128 v[224:227], v30
    ds_read_b128 v[212:215], v11 offset:32768
    ds_read_b128 v[228:231], v31
    s_mov_b32 s36, 2
    s_waitcnt lgkmcnt(6)
    v_mfma_f32_16x16x32_bf16 v[232:235], v[200:203], v[32:35], v[188:191]
    v_mfma_f32_16x16x32_bf16 v[236:239], v[216:219], v[32:35], v[188:191]
    s_waitcnt lgkmcnt(4)
    v_mfma_f32_16x16x32_bf16 v[232:235], v[204:207], v[44:47], v[232:235]
    v_mfma_f32_16x16x32_bf16 v[236:239], v[220:223], v[44:47], v[236:239]
    s_waitcnt lgkmcnt(2)
    v_mfma_f32_16x16x32_bf16 v[232:235], v[208:211], v[56:59], v[232:235]
    v_mfma_f32_16x16x32_bf16 v[236:239], v[224:227], v[56:59], v[236:239]
    s_waitcnt lgkmcnt(0)
    v_mfma_f32_16x16x32_bf16 v[232:235], v[212:215], v[68:71], v[232:235]
    v_mfma_f32_16x16x32_bf16 v[236:239], v[228:231], v[68:71], v[236:239]
    v_mfma_f32_16x16x32_bf16 v[240:243], v[200:203], v[36:39], v[192:195]
    s_add_u32 m0, s28, 98304
    s_add_u32 s30, s25, 28672
    buffer_load_dwordx4 v2, s[48:51], s30 offen offset:0 lds
    v_mfma_f32_16x16x32_bf16 v[244:247], v[216:219], v[36:39], v[192:195]
    v_mfma_f32_16x16x32_bf16 v[240:243], v[204:207], v[48:51], v[240:243]
    buffer_load_dwordx4 v3, s[48:51], s30 offen offset:1024 lds
    v_max3_f32 v24, v232, v233, v234
    v_max3_f32 v25, v236, v237, v238
    v_max3_f32 v24, v24, v235, v239
    v_mfma_f32_16x16x32_bf16 v[244:247], v[220:223], v[48:51], v[244:247]
    v_max_f32 v24, v24, v25
    v_cmp_lt_f32 vcc, 0x41000000, v24
    s_cbranch_vccnz L_rare0
L_back2_0:
    v_mfma_f32_16x16x32_bf16 v[240:243], v[208:211], v[60:63], v[240:243]
    buffer_load_dwordx4 v2, s[48:51], s30 offen offset:2048 lds
    v_exp_f32 v232, v232
    v_exp_f32 v233, v233
    v_exp_f32 v234, v234
    v_mfma_f32_16x16x32_bf16 v[244:247], v[224:227], v[60:63], v[244:247]
    v_exp_f32 v235, v235
    v_exp_f32 v236, v236
    v_exp_f32 v237, v237
    v_mfma_f32_16x16x32_bf16 v[240:243], v[212:215], v[72:75], v[240:243]
    buffer_load_dwordx4 v3, s[48:51], s30 offen offset:3072 lds
    v_exp_f32 v238, v238
    v_exp_f32 v239, v239
    v_cvt_pk_bf16_f32 v232, v232, v233
    v_mfma_f32_16x16x32_bf16 v[244:247], v[228:231], v[72:75], v[244:247]
    v_cvt_pk_bf16_f32 v233, v234, v235
    v_cvt_pk_bf16_f32 v234, v236, v237
    v_cvt_pk_bf16_f32 v235, v238, v239
    v_mfma_f32_16x16x32_bf16 v[248:251], v[200:203], v[40:43], v[196:199]
    s_add_u32 m0, s28, 131072
    s_add_u32 s30, s25, 32768
    buffer_load_dwordx4 v2, s[48:51], s30 offen offset:0 lds
    v_mfma_f32_16x16x32_bf16 v[252:255], v[216:219], v[40:43], v[196:199]
    v_mfma_f32_16x16x32_bf16 v[248:251], v[204:207], v[52:55], v[248:251]
    buffer_load_dwordx4 v3, s[48:51], s30 offen offset:1024 lds
    v_max3_f32 v24, v240, v241, v242
    v_max3_f32 v25, v244, v245, v246
    v_max3_f32 v24, v24, v243, v247
    v_mfma_f32_16x16x32_bf16 v[252:255], v[220:223], v[52:55], v[252:255]
    v_max_f32 v24, v24, v25
    v_cmp_lt_f32 vcc, 0x41000000, v24
    s_cbranch_vccnz L_rare1
L_back2_1:
    v_mfma_f32_16x16x32_bf16 v[248:251], v[208:211], v[64:67], v[248:251]
    buffer_load_dwordx4 v2, s[48:51], s30 offen offset:2048 lds
    v_exp_f32 v240, v240
    v_exp_f32 v241, v241
    v_exp_f32 v242, v242
    v_mfma_f32_16x16x32_bf16 v[252:255], v[224:227], v[64:67], v[252:255]
    v_exp_f32 v243, v243
    v_exp_f32 v244, v244
    v_exp_f32 v245, v245
    v_mfma_f32_16x16x32_bf16 v[248:251], v[212:215], v[76:79], v[248:251]
    buffer_load_dwordx4 v3, s[48:51], s30 offen offset:3072 lds
    v_exp_f32 v246, v246
    v_exp_f32 v247, v247
    v_cvt_pk_bf16_f32 v240, v240, v241
    v_mfma_f32_16x16x32_bf16 v[252:255], v[228:231], v[76:79], v[252:255]
    v_cvt_pk_bf16_f32 v241, v242, v243
    v_cvt_pk_bf16_f32 v242, v244, v245
    v_cvt_pk_bf16_f32 v243, v246, v247
    s_waitcnt vmcnt(8)
    ds_read_b64_tr_b16 v[200:201], v12 offset:0
    ds_read_b64_tr_b16 v[202:203], v12 offset:32768
    ds_read_b64_tr_b16 v[204:205], v13 offset:0
    ds_read_b64_tr_b16 v[206:207], v13 offset:32768
    ds_read_b64_tr_b16 v[208:209], v14 offset:0
    ds_read_b64_tr_b16 v[210:211], v14 offset:32768
    ds_read_b64_tr_b16 v[212:213], v15 offset:0
    ds_read_b64_tr_b16 v[214:215], v15 offset:32768
    ds_read_b64_tr_b16 v[216:217], v16 offset:0
    ds_read_b64_tr_b16 v[218:219], v16 offset:32768
    ds_read_b64_tr_b16 v[220:221], v17 offset:0
    ds_read_b64_tr_b16 v[222:223], v17 offset:32768
    ds_read_b64_tr_b16 v[224:225], v18 offset:0
    ds_read_b64_tr_b16 v[226:227], v18 offset:32768
    ds_read_b64_tr_b16 v[228:229], v19 offset:0
    ds_read_b64_tr_b16 v[230:231], v19 offset:32768
    v_mfma_f32_16x16x32_bf16 v[176:179], v[20:23], v[232:235], v[176:179]
    v_mfma_f32_16x16x32_bf16 v[180:183], v[20:23], v[240:243], v[180:183]
    v_max3_f32 v24, v248, v249, v250
    v_max3_f32 v25, v252, v253, v254
    v_max3_f32 v24, v24, v251, v255
    v_max_f32 v24, v24, v25
    v_cmp_lt_f32 vcc, 0x41000000, v24
    s_cbranch_vccnz L_rare2
L_back2_2:
    v_exp_f32 v248, v248
    v_exp_f32 v249, v249
    v_exp_f32 v250, v250
    v_exp_f32 v251, v251
    v_exp_f32 v252, v252
    v_exp_f32 v253, v253
    v_exp_f32 v254, v254
    v_exp_f32 v255, v255
    v_cvt_pk_bf16_f32 v248, v248, v249
    v_cvt_pk_bf16_f32 v249, v250, v251
    v_cvt_pk_bf16_f32 v250, v252, v253
    v_cvt_pk_bf16_f32 v251, v254, v255
    s_waitcnt lgkmcnt(12)
    v_mfma_f32_16x16x32_bf16 v[80:83], v[200:203], v[232:235], v[80:83]
    v_mfma_f32_16x16x32_bf16 v[92:95], v[204:207], v[232:235], v[92:95]
    s_waitcnt lgkmcnt(8)
    v_mfma_f32_16x16x32_bf16 v[104:107], v[208:211], v[232:235], v[104:107]
    v_mfma_f32_16x16x32_bf16 v[116:119], v[212:215], v[232:235], v[116:119]
    s_waitcnt lgkmcnt(4)
    v_mfma_f32_16x16x32_bf16 v[128:131], v[216:219], v[232:235], v[128:131]
    v_mfma_f32_16x16x32_bf16 v[140:143], v[220:223], v[232:235], v[140:143]
    s_waitcnt lgkmcnt(0)
    v_mfma_f32_16x16x32_bf16 v[152:155], v[224:227], v[232:235], v[152:155]
    v_mfma_f32_16x16x32_bf16 v[164:167], v[228:231], v[232:235], v[164:167]
    v_mfma_f32_16x16x32_bf16 v[84:87], v[200:203], v[240:243], v[84:87]
    s_add_u32 m0, s28, 0
    s_add_u32 s30, s25, 24576
    buffer_load_dwordx4 v2, s[52:55], s30 offen offset:0 lds
    v_mfma_f32_16x16x32_bf16 v[96:99], v[204:207], v[240:243], v[96:99]
    buffer_load_dwordx4 v3, s[52:55], s30 offen offset:1024 lds
    v_mfma_f32_16x16x32_bf16 v[108:111], v[208:211], v[240:243], v[108:111]
    buffer_load_dwordx4 v2, s[52:55], s30 offen offset:2048 lds
    v_mfma_f32_16x16x32_bf16 v[120:123], v[212:215], v[240:243], v[120:123]
    buffer_load_dwordx4 v3, s[52:55], s30 offen offset:3072 lds
    v_mfma_f32_16x16x32_bf16 v[132:135], v[216:219], v[240:243], v[132:135]
    s_add_u32 m0, s28, 32768
    s_add_u32 s30, s25, 28672
    buffer_load_dwordx4 v2, s[52:55], s30 offen offset:0 lds
    v_mfma_f32_16x16x32_bf16 v[144:147], v[220:223], v[240:243], v[144:147]
    buffer_load_dwordx4 v3, s[52:55], s30 offen offset:1024 lds
    v_mfma_f32_16x16x32_bf16 v[156:159], v[224:227], v[240:243], v[156:159]
    buffer_load_dwordx4 v2, s[52:55], s30 offen offset:2048 lds
    v_mfma_f32_16x16x32_bf16 v[168:171], v[228:231], v[240:243], v[168:171]
    buffer_load_dwordx4 v3, s[52:55], s30 offen offset:3072 lds
    v_mfma_f32_16x16x32_bf16 v[184:187], v[20:23], v[248:251], v[184:187]
    v_mfma_f32_16x16x32_bf16 v[88:91], v[200:203], v[248:251], v[88:91]
    v_mfma_f32_16x16x32_bf16 v[100:103], v[204:207], v[248:251], v[100:103]
    v_mfma_f32_16x16x32_bf16 v[112:115], v[208:211], v[248:251], v[112:115]
    v_mfma_f32_16x16x32_bf16 v[124:127], v[212:215], v[248:251], v[124:127]
    v_mfma_f32_16x16x32_bf16 v[136:139], v[216:219], v[248:251], v[136:139]
    v_mfma_f32_16x16x32_bf16 v[148:151], v[220:223], v[248:251], v[148:151]
    v_mfma_f32_16x16x32_bf16 v[160:163], v[224:227], v[248:251], v[160:163]
    v_mfma_f32_16x16x32_bf16 v[172:175], v[228:231], v[248:251], v[172:175]
    s_cmp_lg_u32 s21, 6
    s_cbranch_scc1 L_st10
    buffer_load_dword v1, v7, s[48:51], s41 offen
    buffer_load_dword v1, v7, s[52:55], s41 offen
L_st10:
    s_waitcnt vmcnt(12)
    ds_read_b128 v[200:203], v8 offset:0
    ds_read_b128 v[216:219], v8 offset:32768
    ds_read_b128 v[204:207], v9 offset:0
    ds_read_b128 v[220:223], v9 offset:32768
    ds_read_b128 v[208:211], v10 offset:0
    ds_read_b128 v[224:227], v10 offset:32768
    ds_read_b128 v[212:215], v11 offset:0
    ds_read_b128 v[228:231], v11 offset:32768
    s_mov_b32 s36, 3
    s_waitcnt lgkmcnt(6)
    v_mfma_f32_16x16x32_bf16 v[232:235], v[200:203], v[32:35], v[188:191]
    v_mfma_f32_16x16x32_bf16 v[236:239], v[216:219], v[32:35], v[188:191]
    s_waitcnt lgkmcnt(4)
    v_mfma_f32_16x16x32_bf16 v[232:235], v[204:207], v[44:47], v[232:235]
    v_mfma_f32_16x16x32_bf16 v[236:239], v[220:223], v[44:47], v[236:239]
    s_waitcnt lgkmcnt(2)
    v_mfma_f32_16x16x32_bf16 v[232:235], v[208:211], v[56:59], v[232:235]
    v_mfma_f32_16x16x32_bf16 v[236:239], v[224:227], v[56:59], v[236:239]
    s_waitcnt lgkmcnt(0)
    v_mfma_f32_16x16x32_bf16 v[232:235], v[212:215], v[68:71], v[232:235]
    v_mfma_f32_16x16x32_bf16 v[236:239], v[228:231], v[68:71], v[236:239]
    v_mfma_f32_16x16x32_bf16 v[240:243], v[200:203], v[36:39], v[192:195]
    s_add_u32 m0, s28, 65536
    s_add_u32 s30, s25, 36864
    buffer_load_dwordx4 v2, s[48:51], s30 offen offset:0 lds
    v_mfma_f32_16x16x32_bf16 v[244:247], v[216:219], v[36:39], v[192:195]
    v_mfma_f32_16x16x32_bf16 v[240:243], v[204:207], v[48:51], v[240:243]
    buffer_load_dwordx4 v3, s[48:51], s30 offen offset:1024 lds
    v_max3_f32 v24, v232, v233, v234
    v_max3_f32 v25, v236, v237, v238
    v_max3_f32 v24, v24, v235, v239
    v_mfma_f32_16x16x32_bf16 v[244:247], v[220:223], v[48:51], v[244:247]
    v_max_f32 v24, v24, v25
    v_cmp_lt_f32 vcc, 0x41000000, v24
    s_cbranch_vccnz L_rare0
L_back3_0:
    v_mfma_f32_16x16x32_bf16 v[240:243], v[208:211], v[60:63], v[240:243]
    buffer_load_dwordx4 v2, s[48:51], s30 offen offset:2048 lds
    v_exp_f32 v232, v232
    v_exp_f32 v233, v233
    v_exp_f32 v234, v234
    v_mfma_f32_16x16x32_bf16 v[244:247], v[224:227], v[60:63], v[244:247]
    v_exp_f32 v235, v235
    v_exp_f32 v236, v236
    v_exp_f32 v237, v237
    v_mfma_f32_16x16x32_bf16 v[240:243], v[212:215], v[72:75], v[240:243]
    buffer_load_dwordx4 v3, s[48:51], s30 offen offset:3072 lds
    v_exp_f32 v238, v238
    v_exp_f32 v239, v239
    v_cvt_pk_bf16_f32 v232, v232, v233
    v_mfma_f32_16x16x32_bf16 v[244:247], v[228:231], v[72:75], v[244:247]
    v_cvt_pk_bf16_f32 v233, v234, v235
    v_cvt_pk_bf16_f32 v234, v236, v237
    v_cvt_pk_bf16_f32 v235, v238, v239
    v_mfma_f32_16x16x32_bf16 v[248:251], v[200:203], v[40:43], v[196:199]
    s_add_u32 m0, s28, 98304
    s_add_u32 s30, s25, 40960
    buffer_load_dwordx4 v2, s[48:51], s30 offen offset:0 lds
    v_mfma_f32_16x16x32_bf16 v[252:255], v[216:219], v[40:43], v[196:199]
    v_mfma_f32_16x16x32_bf16 v[248:251], v[204:207], v[52:55], v[248:251]
    buffer_load_dwordx4 v3, s[48:51], s30 offen offset:1024 lds
    v_max3_f32 v24, v240, v241, v242
    v_max3_f32 v25, v244, v245, v246
    v_max3_f32 v24, v24, v243, v247
    v_mfma_f32_16x16x32_bf16 v[252:255], v[220:223], v[52:55], v[252:255]
    v_max_f32 v24, v24, v25
    v_cmp_lt_f32 vcc, 0x41000000, v24
    s_cbranch_vccnz L_rare1
L_back3_1:
    v_mfma_f32_16x16x32_bf16 v[248:251], v[208:211], v[64:67], v[248:251]
    buffer_load_dwordx4 v2, s[48:51], s30 offen offset:2048 lds
    v_exp_f32 v240, v240
    v_exp_f32 v241, v241
    v_exp_f32 v242, v242
    v_mfma_f32_16x16x32_bf16 v[252:255], v[224:227], v[64:67], v[252:255]
    v_exp_f32 v243, v243
    v_exp_f32 v244, v244
    v_exp_f32 v245, v245
    v_mfma_f32_16x16x32_bf16 v[248:251], v[212:215], v[76:79], v[248:251]
    buffer_load_dwordx4 v3, s[48:51], s30 offen offset:3072 lds
    v_exp_f32 v246, v246
    v_exp_f32 v247, v247
    v_cvt_pk_bf16_f32 v240, v240, v241
    v_mfma_f32_16x16x32_bf16 v[252:255], v[228:231], v[76:79], v[252:255]
    v_cvt_pk_bf16_f32 v241, v242, v243
    v_cvt_pk_bf16_f32 v242, v244, v245
    v_cvt_pk_bf16_f32 v243, v246, v247
    s_waitcnt vmcnt(8)
    ds_read_b64_tr_b16 v[200:201], v12 offset:0
    ds_read_b64_tr_b16 v[202:203], v12 offset:32768
    ds_read_b64_tr_b16 v[204:205], v13 offset:0
    ds_read_b64_tr_b16 v[206:207], v13 offset:32768
    ds_read_b64_tr_b16 v[208:209], v14 offset:0
    ds_read_b64_tr_b16 v[210:211], v14 offset:32768
    ds_read_b64_tr_b16 v[212:213], v15 offset:0
    ds_read_b64_tr_b16 v[214:215], v15 offset:32768
    ds_read_b64_tr_b16 v[216:217], v16 offset:0
    ds_read_b64_tr_b16 v[218:219], v16 offset:32768
    ds_read_b64_tr_b16 v[220:221], v17 offset:0
    ds_read_b64_tr_b16 v[222:223], v17 offset:32768
    ds_read_b64_tr_b16 v[224:225], v18 offset:0
    ds_read_b64_tr_b16 v[226:227], v18 offset:32768
    ds_read_b64_tr_b16 v[228:229], v19 offset:0
    ds_read_b64_tr_b16 v[230:231], v19 offset:32768
    v_mfma_f32_16x16x32_bf16 v[176:179], v[20:23], v[232:235], v[176:179]
    v_mfma_f32_16x16x32_bf16 v[180:183], v[20:23], v[240:243], v[180:183]
    v_max3_f32 v24, v248, v249, v250
    v_max3_f32 v25, v252, v253, v254
    v_max3_f32 v24, v24, v251, v255
    v_max_f32 v24, v24, v25
    v_cmp_lt_f32 vcc, 0x41000000, v24
    s_cbranch_vccnz L_rare2
L_back3_2:
    v_exp_f32 v248, v248
    v_exp_f32 v249, v249
    v_exp_f32 v250, v250
    v_exp_f32 v251, v251
    v_exp_f32 v252, v252
    v_exp_f32 v253, v253
    v_exp_f32 v254, v254
    v_exp_f32 v255, v255
    v_cvt_pk_bf16_f32 v248, v248, v249
    v_cvt_pk_bf16_f32 v249, v250, v251
    v_cvt_pk_bf16_f32 v250, v252, v253
    v_cvt_pk_bf16_f32 v251, v254, v255
    s_waitcnt lgkmcnt(12)
    v_mfma_f32_16x16x32_bf16 v[80:83], v[200:203], v[232:235], v[80:83]
    v_mfma_f32_16x16x32_bf16 v[92:95], v[204:207], v[232:235], v[92:95]
    s_waitcnt lgkmcnt(8)
    v_mfma_f32_16x16x32_bf16 v[104:107], v[208:211], v[232:235], v[104:107]
    v_mfma_f32_16x16x32_bf16 v[116:119], v[212:215], v[232:235], v[116:119]
    s_waitcnt lgkmcnt(4)
    v_mfma_f32_16x16x32_bf16 v[128:131], v[216:219], v[232:235], v[128:131]
    v_mfma_f32_16x16x32_bf16 v[140:143], v[220:223], v[232:235], v[140:143]
    s_waitcnt lgkmcnt(0)
    v_mfma_f32_16x16x32_bf16 v[152:155], v[224:227], v[232:235], v[152:155]
    v_mfma_f32_16x16x32_bf16 v[164:167], v[228:231], v[232:235], v[164:167]
    v_mfma_f32_16x16x32_bf16 v[84:87], v[200:203], v[240:243], v[84:87]
    s_add_u32 m0, s28, 0
    s_add_u32 s30, s25, 32768
    buffer_load_dwordx4 v2, s[52:55], s30 offen offset:0 lds
    v_mfma_f32_16x16x32_bf16 v[96:99], v[204:207], v[240:243], v[96:99]
    buffer_load_dwordx4 v3, s[52:55], s30 offen offset:1024 lds
    v_mfma_f32_16x16x32_bf16 v[108:111], v[208:211], v[240:243], v[108:111]
    buffer_load_dwordx4 v2, s[52:55], s30 offen offset:2048 lds
    v_mfma_f32_16x16x32_bf16 v[120:123], v[212:215], v[240:243], v[120:123]
    buffer_load_dwordx4 v3, s[52:55], s30 offen offset:3072 lds
    v_mfma_f32_16x16x32_bf16 v[132:135], v[216:219], v[240:243], v[132:135]
    s_add_u32 m0, s28, 32768
    s_add_u32 s30, s25, 36864
    buffer_load_dwordx4 v2, s[52:55], s30 offen offset:0 lds
    v_mfma_f32_16x16x32_bf16 v[144:147], v[220:223], v[240:243], v[144:147]
    buffer_load_dwordx4 v3, s[52:55], s30 offen offset:1024 lds
    v_mfma_f32_16x16x32_bf16 v[156:159], v[224:227], v[240:243], v[156:159]
    buffer_load_dwordx4 v2, s[52:55], s30 offen offset:2048 lds
    v_mfma_f32_16x16x32_bf16 v[168:171], v[228:231], v[240:243], v[168:171]
    buffer_load_dwordx4 v3, s[52:55], s30 offen offset:3072 lds
    v_mfma_f32_16x16x32_bf16 v[184:187], v[20:23], v[248:251], v[184:187]
    v_mfma_f32_16x16x32_bf16 v[88:91], v[200:203], v[248:251], v[88:91]
    v_mfma_f32_16x16x32_bf16 v[100:103], v[204:207], v[248:251], v[100:103]
    v_mfma_f32_16x16x32_bf16 v[112:115], v[208:211], v[248:251], v[112:115]
    v_mfma_f32_16x16x32_bf16 v[124:127], v[212:215], v[248:251], v[124:127]
    v_mfma_f32_16x16x32_bf16 v[136:139], v[216:219], v[248:251], v[136:139]
    v_mfma_f32_16x16x32_bf16 v[148:151], v[220:223], v[248:251], v[148:151]
    v_mfma_f32_16x16x32_bf16 v[160:163], v[224:227], v[248:251], v[160:163]
    v_mfma_f32_16x16x32_bf16 v[172:175], v[228:231], v[248:251], v[172:175]
    s_cmp_lg_u32 s21, 7
    s_cbranch_scc1 L_st11
    buffer_load_dword v1, v7, s[48:51], s41 offen
    buffer_load_dword v1, v7, s[52:55], s41 offen
L_st11:
    s_waitcnt vmcnt(12)
    ds_read_b128 v[200:203], v28
    ds_read_b128 v[216:219], v8 offset:0
    ds_read_b128 v[204:207], v29
    ds_read_b128 v[220:223], v9 offset:0
    ds_read_b128 v[208:211], v30
    ds_read_b128 v[224:227], v10 offset:0
    ds_read_b128 v[212:215], v31
    ds_read_b128 v[228:231], v11 offset:0
    s_mov_b32 s36, 4
    s_waitcnt lgkmcnt(6)
    v_mfma_f32_16x16x32_bf16 v[232:235], v[200:203], v[32:35], v[188:191]
    v_mfma_f32_16x16x32_bf16 v[236:239], v[216:219], v[32:35], v[188:191]
    s_waitcnt lgkmcnt(4)
    v_mfma_f32_16x16x32_bf16 v[232:235], v[204:207], v[44:47], v[232:235]
    v_mfma_f32_16x16x32_bf16 v[236:239], v[220:223], v[44:47], v[236:239]
    s_waitcnt lgkmcnt(2)
    v_mfma_f32_16x16x32_bf16 v[232:235], v[208:211], v[56:59], v[232:235]
    v_mfma_f32_16x16x32_bf16 v[236:239], v[224:227], v[56:59], v[236:239]
    s_waitcnt lgkmcnt(0)
    v_mfma_f32_16x16x32_bf16 v[232:235], v[212:215], v[68:71], v[232:235]
    v_mfma_f32_16x16x32_bf16 v[236:239], v[228:231], v[68:71], v[236:239]
    v_mfma_f32_16x16x32_bf16 v[240:243], v[200:203], v[36:39], v[192:195]
    s_add_u32 m0, s28, 131072
    s_add_u32 s30, s25, 45056
    buffer_load_dwordx4 v2, s[48:51], s30 offen offset:0 lds
    v_mfma_f32_16x16x32_bf16 v[244:247], v[216:219], v[36:39], v[192:195]
    v_mfma_f32_16x16x32_bf16 v[240:243], v[204:207], v[48:51], v[240:243]
    buffer_load_dwordx4 v3, s[48:51], s30 offen offset:1024 lds
    v_max3_f32 v24, v232, v233, v234
    v_max3_f32 v25, v236, v237, v238
    v_max3_f32 v24, v24, v235, v239
    v_mfma_f32_16x16x32_bf16 v[244:247], v[220:223], v[48:51], v[244:247]
    v_max_f32 v24, v24, v25
    v_cmp_lt_f32 vcc, 0x41000000, v24
    s_cbranch_vccnz L_rare0
L_back4_0:
    v_mfma_f32_16x16x32_bf16 v[240:243], v[208:211], v[60:63], v[240:243]
    buffer_load_dwordx4 v2, s[48:51], s30 offen offset:2048 lds
    v_exp_f32 v232, v232
    v_exp_f32 v233, v233
    v_exp_f32 v234, v234
    v_mfma_f32_16x16x32_bf16 v[244:247], v[224:227], v[60:63], v[244:247]
    v_exp_f32 v235, v235
    v_exp_f32 v236, v236
    v_exp_f32 v237, v237
    v_mfma_f32_16x16x32_bf16 v[240:243], v[212:215], v[72:75], v[240:243]
    buffer_load_dwordx4 v3, s[48:51], s30 offen offset:3072 lds
    v_exp_f32 v238, v238
    v_exp_f32 v239, v239
    v_cvt_pk_bf16_f32 v232, v232, v233
    v_mfma_f32_16x16x32_bf16 v[244:247], v[228:231], v[72:75], v[244:247]
    v_cvt_pk_bf16_f32 v233, v234, v235
    v_cvt_pk_bf16_f32 v234, v236, v237
    v_cvt_pk_bf16_f32 v235, v238, v239
    v_mfma_f32_16x16x32_bf16 v[248:251], v[200:203], v[40:43], v[196:199]
    s_add_u32 m0, s28, 65536
    s_add_u32 s30, s25, 49152
    buffer_load_dwordx4 v2, s[48:51], s30 offen offset:0 lds
    v_mfma_f32_16x16x32_bf16 v[252:255], v[216:219], v[40:43], v[196:199]
    v_mfma_f32_16x16x32_bf16 v[248:251], v[204:207], v[52:55], v[248:251]
    buffer_load_dwordx4 v3, s[48:51], s30 offen offset:1024 lds
    v_max3_f32 v24, v240, v241, v242
    v_max3_f32 v25, v244, v245, v246
    v_max3_f32 v24, v24, v243, v247
    v_mfma_f32_16x16x32_bf16 v[252:255], v[220:223], v[52:55], v[252:255]
    v_max_f32 v24, v24, v25
    v_cmp_lt_f32 vcc, 0x41000000, v24
    s_cbranch_vccnz L_rare1
L_back4_1:
    v_mfma_f32_16x16x32_bf16 v[248:251], v[208:211], v[64:67], v[248:251]
    buffer_load_dwordx4 v2, s[48:51], s30 offen offset:2048 lds
    v_exp_f32 v240, v240
    v_exp_f32 v241, v241
    v_exp_f32 v242, v242
    v_mfma_f32_16x16x32_bf16 v[252:255], v[224:227], v[64:67], v[252:255]
    v_exp_f32 v243, v243
    v_exp_f32 v244, v244
    v_exp_f32 v245, v245
    v_mfma_f32_16x16x32_bf16 v[248:251], v[212:215], v[76:79], v[248:251]
    buffer_load_dwordx4 v3, s[48:51], s30 offen offset:3072 lds
    v_exp_f32 v246, v246
    v_exp_f32 v247, v247
    v_cvt_pk_bf16_f32 v240, v240, v241
    v_mfma_f32_16x16x32_bf16 v[252:255], v[228:231], v[76:79], v[252:255]
    v_cvt_pk_bf16_f32 v241, v242, v243
    v_cvt_pk_bf16_f32 v242, v244, v245
    v_cvt_pk_bf16_f32 v243, v246, v247
    s_waitcnt vmcnt(8)
    ds_read_b64_tr_b16 v[200:201], v12 offset:0
    ds_read_b64_tr_b16 v[202:203], v12 offset:32768
    ds_read_b64_tr_b16 v[204:205], v13 offset:0
    ds_read_b64_tr_b16 v[206:207], v13 offset:32768
    ds_read_b64_tr_b16 v[208:209], v14 offset:0
    ds_read_b64_tr_b16 v[210:211], v14 offset:32768
    ds_read_b64_tr_b16 v[212:213], v15 offset:0
    ds_read_b64_tr_b16 v[214:215], v15 offset:32768
    ds_read_b64_tr_b16 v[216:217], v16 offset:0
    ds_read_b64_tr_b16 v[218:219], v16 offset:32768
    ds_read_b64_tr_b16 v[220:221], v17 offset:0
    ds_read_b64_tr_b16 v[222:223], v17 offset:32768
    ds_read_b64_tr_b16 v[224:225], v18 offset:0
    ds_read_b64_tr_b16 v[226:227], v18 offset:32768
    ds_read_b64_tr_b16 v[228:229], v19 offset:0
    ds_read_b64_tr_b16 v[230:231], v19 offset:32768
    v_mfma_f32_16x16x32_bf16 v[176:179], v[20:23], v[232:235], v[176:179]
    v_mfma_f32_16x16x32_bf16 v[180:183], v[20:23], v[240:243], v[180:183]
    v_max3_f32 v24, v248, v249, v250
    v_max3_f32 v25, v252, v253, v254
    v_max3_f32 v24, v24, v251, v255
    v_max_f32 v24, v24, v25
    v_cmp_lt_f32 vcc, 0x41000000, v24
    s_cbranch_vccnz L_rare2
L_back4_2:
    v_exp_f32 v248, v248
    v_exp_f32 v249, v249
    v_exp_f32 v250, v250
    v_exp_f32 v251, v251
    v_exp_f32 v252, v252
    v_exp_f32 v253, v253
    v_exp_f32 v254, v254
    v_exp_f32 v255, v255
    v_cvt_pk_bf16_f32 v248, v248, v249
    v_cvt_pk_bf16_f32 v249, v250, v251
    v_cvt_pk_bf16_f32 v250, v252, v253
    v_cvt_pk_bf16_f32 v251, v254, v255
    s_waitcnt lgkmcnt(12)
    v_mfma_f32_16x16x32_bf16 v[80:83], v[200:203], v[232:235], v[80:83]
    v_mfma_f32_16x16x32_bf16 v[92:95], v[204:207], v[232:235], v[92:95]
    s_waitcnt lgkmcnt(8)
    v_mfma_f32_16x16x32_bf16 v[104:107], v[208:211], v[232:235], v[104:107]
    v_mfma_f32_16x16x32_bf16 v[116:119], v[212:215], v[232:235], v[116:119]
    s_waitcnt lgkmcnt(4)
    v_mfma_f32_16x16x32_bf16 v[128:131], v[216:219], v[232:235], v[128:131]
    v_mfma_f32_16x16x32_bf16 v[140:143], v[220:223], v[232:235], v[140:143]
    s_waitcnt lgkmcnt(0)
    v_mfma_f32_16x16x32_bf16 v[152:155], v[224:227], v[232:235], v[152:155]
    v_mfma_f32_16x16x32_bf16 v[164:167], v[228:231], v[232:235], v[164:167]
    v_mfma_f32_16x16x32_bf16 v[84:87], v[200:203], v[240:243], v[84:87]
    s_add_u32 m0, s28, 0
    s_add_u32 s30, s25, 40960
    buffer_load_dwordx4 v2, s[52:55], s30 offen offset:0 lds
    v_mfma_f32_16x16x32_bf16 v[96:99], v[204:207], v[240:243], v[96:99]
    buffer_load_dwordx4 v3, s[52:55], s30 offen offset:1024 lds
    v_mfma_f32_16x16x32_bf16 v[108:111], v[208:211], v[240:243], v[108:111]
    buffer_load_dwordx4 v2, s[52:55], s30 offen offset:2048 lds
    v_mfma_f32_16x16x32_bf16 v[120:123], v[212:215], v[240:243], v[120:123]
    buffer_load_dwordx4 v3, s[52:55], s30 offen offset:3072 lds
    v_mfma_f32_16x16x32_bf16 v[132:135], v[216:219], v[240:243], v[132:135]
    s_add_u32 m0, s28, 32768
    s_add_u32 s30, s25, 45056
    buffer_load_dwordx4 v2, s[52:55], s30 offen offset:0 lds
    v_mfma_f32_16x16x32_bf16 v[144:147], v[220:223], v[240:243], v[144:147]
    buffer_load_dwordx4 v3, s[52:55], s30 offen offset:1024 lds
    v_mfma_f32_16x16x32_bf16 v[156:159], v[224:227], v[240:243], v[156:159]
    buffer_load_dwordx4 v2, s[52:55], s30 offen offset:2048 lds
    v_mfma_f32_16x16x32_bf16 v[168:171], v[228:231], v[240:243], v[168:171]
    buffer_load_dwordx4 v3, s[52:55], s30 offen offset:3072 lds
    v_mfma_f32_16x16x32_bf16 v[184:187], v[20:23], v[248:251], v[184:187]
    v_mfma_f32_16x16x32_bf16 v[88:91], v[200:203], v[248:251], v[88:91]
    v_mfma_f32_16x16x32_bf16 v[100:103], v[204:207], v[248:251], v[100:103]
    v_mfma_f32_16x16x32_bf16 v[112:115], v[208:211], v[248:251], v[112:115]
    v_mfma_f32_16x16x32_bf16 v[124:127], v[212:215], v[248:251], v[124:127]
    v_mfma_f32_16x16x32_bf16 v[136:139], v[216:219], v[248:251], v[136:139]
    v_mfma_f32_16x16x32_bf16 v[148:151], v[220:223], v[248:251], v[148:151]
    v_mfma_f32_16x16x32_bf16 v[160:163], v[224:227], v[248:251], v[160:163]
    v_mfma_f32_16x16x32_bf16 v[172:175], v[228:231], v[248:251], v[172:175]
    s_waitcnt vmcnt(12)
    ds_read_b128 v[200:203], v8 offset:32768
    ds_read_b128 v[216:219], v28
    ds_read_b128 v[204:207], v9 offset:32768
    ds_read_b128 v[220:223], v29
    ds_read_b128 v[208:211], v10 offset:32768
    ds_read_b128 v[224:227], v30
    ds_read_b128 v[212:215], v11 offset:32768
    ds_read_b128 v[228:231], v31
    s_mov_b32 s36, 5
    s_waitcnt lgkmcnt(6)
    v_mfma_f32_16x16x32_bf16 v[232:235], v[200:203], v[32:35], v[188:191]
    v_mfma_f32_16x16x32_bf16 v[236:239], v[216:219], v[32:35], v[188:191]
    s_waitcnt lgkmcnt(4)
    v_mfma_f32_16x16x32_bf16 v[232:235], v[204:207], v[44:47], v[232:235]
    v_mfma_f32_16x16x32_bf16 v[236:239], v[220:223], v[44:47], v[236:239]
    s_waitcnt lgkmcnt(2)
    v_mfma_f32_16x16x32_bf16 v[232:235], v[208:211], v[56:59], v[232:235]
    v_mfma_f32_16x16x32_bf16 v[236:239], v[224:227], v[56:59], v[236:239]
    s_waitcnt lgkmcnt(0)
    v_mfma_f32_16x16x32_bf16 v[232:235], v[212:215], v[68:71], v[232:235]
    v_mfma_f32_16x16x32_bf16 v[236:239], v[228:231], v[68:71], v[236:239]
    v_mfma_f32_16x16x32_bf16 v[240:243], v[200:203], v[36:39], v[192:195]
    s_add_u32 m0, s28, 98304
    s_add_u32 s30, s25, 53248
    buffer_load_dwordx4 v2, s[48:51], s30 offen offset:0 lds
    v_mfma_f32_16x16x32_bf16 v[244:247], v[216:219], v[36:39], v[192:195]
    v_mfma_f32_16x16x32_bf16 v[240:243], v[204:207], v[48:51], v[240:243]
    buffer_load_dwordx4 v3, s[48:51], s30 offen offset:1024 lds
    v_max3_f32 v24, v232, v233, v234
    v_max3_f32 v25, v236, v237, v238
    v_max3_f32 v24, v24, v235, v239
    v_mfma_f32_16x16x32_bf16 v[244:247], v[220:223], v[48:51], v[244:247]
    v_max_f32 v24, v24, v25
    v_cmp_lt_f32 vcc, 0x41000000, v24
    s_cbranch_vccnz L_rare0
L_back5_0:
    v_mfma_f32_16x16x32_bf16 v[240:243], v[208:211], v[60:63], v[240:243]
    buffer_load_dwordx4 v2, s[48:51], s30 offen offset:2048 lds
    v_exp_f32 v232, v232
    v_exp_f32 v233, v233
    v_exp_f32 v234, v234
    v_mfma_f32_16x16x32_bf16 v[244:247], v[224:227], v[60:63], v[244:247]
    v_exp_f32 v235, v235
    v_exp_f32 v236, v236
    v_exp_f32 v237, v237
    v_mfma_f32_16x16x32_bf16 v[240:243], v[212:215], v[72:75], v[240:243]
    buffer_load_dwordx4 v3, s[48:51], s30 offen offset:3072 lds
    v_exp_f32 v238, v238
    v_exp_f32 v239, v239
    v_cvt_pk_bf16_f32 v232, v232, v233
    v_mfma_f32_16x16x32_bf16 v[244:247], v[228:231], v[72:75], v[244:247]
    v_cvt_pk_bf16_f32 v233, v234, v235
    v_cvt_pk_bf16_f32 v234, v236, v237
    v_cvt_pk_bf16_f32 v235, v238, v239
    v_mfma_f32_16x16x32_bf16 v[248:251], v[200:203], v[40:43], v[196:199]
    s_add_u32 m0, s28, 131072
    s_add_u32 s30, s25, 57344
    buffer_load_dwordx4 v2, s[48:51], s30 offen offset:0 lds
    v_mfma_f32_16x16x32_bf16 v[252:255], v[216:219], v[40:43], v[196:199]
    v_mfma_f32_16x16x32_bf16 v[248:251], v[204:207], v[52:55], v[248:251]
    buffer_load_dwordx4 v3, s[48:51], s30 offen offset:1024 lds
    v_max3_f32 v24, v240, v241, v242
    v_max3_f32 v25, v244, v245, v246
    v_max3_f32 v24, v24, v243, v247
    v_mfma_f32_16x16x32_bf16 v[252:255], v[220:223], v[52:55], v[252:255]
    v_max_f32 v24, v24, v25
    v_cmp_lt_f32 vcc, 0x41000000, v24
    s_cbranch_vccnz L_rare1
L_back5_1:
    v_mfma_f32_16x16x32_bf16 v[248:251], v[208:211], v[64:67], v[248:251]
    buffer_load_dwordx4 v2, s[48:51], s30 offen offset:2048 lds
    v_exp_f32 v240, v240
    v_exp_f32 v241, v241
    v_exp_f32 v242, v242
    v_mfma_f32_16x16x32_bf16 v[252:255], v[224:227], v[64:67], v[252:255]
    v_exp_f32 v243, v243
    v_exp_f32 v244, v244
    v_exp_f32 v245, v245
    v_mfma_f32_16x16x32_bf16 v[248:251], v[212:215], v[76:79], v[248:251]
    buffer_load_dwordx4 v3, s[48:51], s30 offen offset:3072 lds
    v_exp_f32 v246, v246
    v_exp_f32 v247, v247
    v_cvt_pk_bf16_f32 v240, v240, v241
    v_mfma_f32_16x16x32_bf16 v[252:255], v[228:231], v[76:79], v[252:255]
    v_cvt_pk_bf16_f32 v241, v242, v243
    v_cvt_pk_bf16_f32 v242, v244, v245
    v_cvt_pk_bf16_f32 v243, v246, v247
    s_waitcnt vmcnt(8)
    ds_read_b64_tr_b16 v[200:201], v12 offset:0
    ds_read_b64_tr_b16 v[202:203], v12 offset:32768
    ds_read_b64_tr_b16 v[204:205], v13 offset:0
    ds_read_b64_tr_b16 v[206:207], v13 offset:32768
    ds_read_b64_tr_b16 v[208:209], v14 offset:0
    ds_read_b64_tr_b16 v[210:211], v14 offset:32768
    ds_read_b64_tr_b16 v[212:213], v15 offset:0
    ds_read_b64_tr_b16 v[214:215], v15 offset:32768
    ds_read_b64_tr_b16 v[216:217], v16 offset:0
    ds_read_b64_tr_b16 v[218:219], v16 offset:32768
    ds_read_b64_tr_b16 v[220:221], v17 offset:0
    ds_read_b64_tr_b16 v[222:223], v17 offset:32768
    ds_read_b64_tr_b16 v[224:225], v18 offset:0
    ds_read_b64_tr_b16 v[226:227], v18 offset:32768
    ds_read_b64_tr_b16 v[228:229], v19 offset:0
    ds_read_b64_tr_b16 v[230:231], v19 offset:32768
    v_mfma_f32_16x16x32_bf16 v[176:179], v[20:23], v[232:235], v[176:179]
    v_mfma_f32_16x16x32_bf16 v[180:183], v[20:23], v[240:243], v[180:183]
    v_max3_f32 v24, v248, v249, v250
    v_max3_f32 v25, v252, v253, v254
    v_max3_f32 v24, v24, v251, v255
    v_max_f32 v24, v24, v25
    v_cmp_lt_f32 vcc, 0x41000000, v24
    s_cbranch_vccnz L_rare2
L_back5_2:
    v_exp_f32 v248, v248
    v_exp_f32 v249, v249
    v_exp_f32 v250, v250
    v_exp_f32 v251, v251
    v_exp_f32 v252, v252
    v_exp_f32 v253, v253
    v_exp_f32 v254, v254
    v_exp_f32 v255, v255
    v_cvt_pk_bf16_f32 v248, v248, v249
    v_cvt_pk_bf16_f32 v249, v250, v251
    v_cvt_pk_bf16_f32 v250, v252, v253
    v_cvt_pk_bf16_f32 v251, v254, v255
    s_waitcnt lgkmcnt(12)
    v_mfma_f32_16x16x32_bf16 v[80:83], v[200:203], v[232:235], v[80:83]
    v_mfma_f32_16x16x32_bf16 v[92:95], v[204:207], v[232:235], v[92:95]
    s_waitcnt lgkmcnt(8)
    v_mfma_f32_16x16x32_bf16 v[104:107], v[208:211], v[232:235], v[104:107]
    v_mfma_f32_16x16x32_bf16 v[116:119], v[212:215], v[232:235], v[116:119]
    s_waitcnt lgkmcnt(4)
    v_mfma_f32_16x16x32_bf16 v[128:131], v[216:219], v[232:235], v[128:131]
    v_mfma_f32_16x16x32_bf16 v[140:143], v[220:223], v[232:235], v[140:143]
    s_waitcnt lgkmcnt(0)
    v_mfma_f32_16x16x32_bf16 v[152:155], v[224:227], v[232:235], v[152:155]
    v_mfma_f32_16x16x32_bf16 v[164:167], v[228:231], v[232:235], v[164:167]
    v_mfma_f32_16x16x32_bf16 v[84:87], v[200:203], v[240:243], v[84:87]
    s_add_u32 m0, s28, 0
    s_add_u32 s30, s25, 49152
    buffer_load_dwordx4 v2, s[52:55], s30 offen offset:0 lds
    v_mfma_f32_16x16x32_bf16 v[96:99], v[204:207], v[240:243], v[96:99]
    buffer_load_dwordx4 v3, s[52:55], s30 offen offset:1024 lds
    v_mfma_f32_16x16x32_bf16 v[108:111], v[208:211], v[240:243], v[108:111]
    buffer_load_dwordx4 v2, s[52:55], s30 offen offset:2048 lds
    v_mfma_f32_16x16x32_bf16 v[120:123], v[212:215], v[240:243], v[120:123]
    buffer_load_dwordx4 v3, s[52:55], s30 offen offset:3072 lds
    v_mfma_f32_16x16x32_bf16 v[132:135], v[216:219], v[240:243], v[132:135]
    s_add_u32 m0, s28, 32768
    s_add_u32 s30, s25, 53248
    buffer_load_dwordx4 v2, s[52:55], s30 offen offset:0 lds
    v_mfma_f32_16x16x32_bf16 v[144:147], v[220:223], v[240:243], v[144:147]
    buffer_load_dwordx4 v3, s[52:55], s30 offen offset:1024 lds
    v_mfma_f32_16x16x32_bf16 v[156:159], v[224:227], v[240:243], v[156:159]
    buffer_load_dwordx4 v2, s[52:55], s30 offen offset:2048 lds
    v_mfma_f32_16x16x32_bf16 v[168:171], v[228:231], v[240:243], v[168:171]
    buffer_load_dwordx4 v3, s[52:55], s30 offen offset:3072 lds
    v_mfma_f32_16x16x32_bf16 v[184:187], v[20:23], v[248:251], v[184:187]
    v_mfma_f32_16x16x32_bf16 v[88:91], v[200:203], v[248:251], v[88:91]
    v_mfma_f32_16x16x32_bf16 v[100:103], v[204:207], v[248:251], v[100:103]
    v_mfma_f32_16x16x32_bf16 v[112:115], v[208:211], v[248:251], v[112:115]
    v_mfma_f32_16x16x32_bf16 v[124:127], v[212:215], v[248:251], v[124:127]
    v_mfma_f32_16x16x32_bf16 v[136:139], v[216:219], v[248:251], v[136:139]
    v_mfma_f32_16x16x32_bf16 v[148:151], v[220:223], v[248:251], v[148:151]
    v_mfma_f32_16x16x32_bf16 v[160:163], v[224:227], v[248:251], v[160:163]
    v_mfma_f32_16x16x32_bf16 v[172:175], v[228:231], v[248:251], v[172:175]
    s_waitcnt vmcnt(12)
    ds_read_b128 v[200:203], v8 offset:0
    ds_read_b128 v[216:219], v8 offset:32768
    ds_read_b128 v[204:207], v9 offset:0
    ds_read_b128 v[220:223], v9 offset:32768
    ds_read_b128 v[208:211], v10 offset:0
    ds_read_b128 v[224:227], v10 offset:32768
    ds_read_b128 v[212:215], v11 offset:0
    ds_read_b128 v[228:231], v11 offset:32768
    s_mov_b32 s36, 6
    s_waitcnt lgkmcnt(6)
    v_mfma_f32_16x16x32_bf16 v[232:235], v[200:203], v[32:35], v[188:191]
    v_mfma_f32_16x16x32_bf16 v[236:239], v[216:219], v[32:35], v[188:191]
    s_waitcnt lgkmcnt(4)
    v_mfma_f32_16x16x32_bf16 v[232:235], v[204:207], v[44:47], v[232:235]
    v_mfma_f32_16x16x32_bf16 v[236:239], v[220:223], v[44:47], v[236:239]
    s_waitcnt lgkmcnt(2)
    v_mfma_f32_16x16x32_bf16 v[232:235], v[208:211], v[56:59], v[232:235]
    v_mfma_f32_16x16x32_bf16 v[236:239], v[224:227], v[56:59], v[236:239]
    s_waitcnt lgkmcnt(0)
    v_mfma_f32_16x16x32_bf16 v[232:235], v[212:215], v[68:71], v[232:235]
    v_mfma_f32_16x16x32_bf16 v[236:239], v[228:231], v[68:71], v[236:239]
    v_mfma_f32_16x16x32_bf16 v[240:243], v[200:203], v[36:39], v[192:195]
    s_add_u32 m0, s28, 65536
    s_add_u32 s30, s25, 61440
    buffer_load_dwordx4 v2, s[48:51], s30 offen offset:0 lds
    v_mfma_f32_16x16x32_bf16 v[244:247], v[216:219], v[36:39], v[192:195]
    v_mfma_f32_16x16x32_bf16 v[240:243], v[204:207], v[48:51], v[240:243]
    buffer_load_dwordx4 v3, s[48:51], s30 offen offset:1024 lds
    v_max3_f32 v24, v232, v233, v234
    v_max3_f32 v25, v236, v237, v238
    v_max3_f32 v24, v24, v235, v239
    v_mfma_f32_16x16x32_bf16 v[244:247], v[220:223], v[48:51], v[244:247]
    v_max_f32 v24, v24, v25
    v_cmp_lt_f32 vcc, 0x41000000, v24
    s_cbranch_vccnz L_rare0
L_back6_0:
    v_mfma_f32_16x16x32_bf16 v[240:243], v[208:211], v[60:63], v[240:243]
    buffer_load_dwordx4 v2, s[48:51], s30 offen offset:2048 lds
    v_exp_f32 v232, v232
    v_exp_f32 v233, v233
    v_exp_f32 v234, v234
    v_mfma_f32_16x16x32_bf16 v[244:247], v[224:227], v[60:63], v[244:247]
    v_exp_f32 v235, v235
    v_exp_f32 v236, v236
    v_exp_f32 v237, v237
    v_mfma_f32_16x16x32_bf16 v[240:243], v[212:215], v[72:75], v[240:243]
    buffer_load_dwordx4 v3, s[48:51], s30 offen offset:3072 lds
    v_exp_f32 v238, v238
    v_exp_f32 v239, v239
    v_cvt_pk_bf16_f32 v232, v232, v233
    v_mfma_f32_16x16x32_bf16 v[244:247], v[228:231], v[72:75], v[244:247]
    v_cvt_pk_bf16_f32 v233, v234, v235
    v_cvt_pk_bf16_f32 v234, v236, v237
    v_cvt_pk_bf16_f32 v235, v238, v239
    v_mfma_f32_16x16x32_bf16 v[248:251], v[200:203], v[40:43], v[196:199]
    v_mfma_f32_16x16x32_bf16 v[252:255], v[216:219], v[40:43], v[196:199]
    v_mfma_f32_16x16x32_bf16 v[248:251], v[204:207], v[52:55], v[248:251]
    v_max3_f32 v24, v240, v241, v242
    v_max3_f32 v25, v244, v245, v246
    v_max3_f32 v24, v24, v243, v247
    v_mfma_f32_16x16x32_bf16 v[252:255], v[220:223], v[52:55], v[252:255]
    v_max_f32 v24, v24, v25
    v_cmp_lt_f32 vcc, 0x41000000, v24
    s_cbranch_vccnz L_rare1
L_back6_1:
    v_mfma_f32_16x16x32_bf16 v[248:251], v[208:211], v[64:67], v[248:251]
    v_exp_f32 v240, v240
    v_exp_f32 v241, v241
    v_exp_f32 v242, v242
    v_mfma_f32_16x16x32_bf16 v[252:255], v[224:227], v[64:67], v[252:255]
    v_exp_f32 v243, v243
    v_exp_f32 v244, v244
    v_exp_f32 v245, v245
    v_mfma_f32_16x16x32_bf16 v[248:251], v[212:215], v[76:79], v[248:251]
    v_exp_f32 v246, v246
    v_exp_f32 v247, v247
    v_cvt_pk_bf16_f32 v240, v240, v241
    v_mfma_f32_16x16x32_bf16 v[252:255], v[228:231], v[76:79], v[252:255]
    v_cvt_pk_bf16_f32 v241, v242, v243
    v_cvt_pk_bf16_f32 v242, v244, v245
    v_cvt_pk_bf16_f32 v243, v246, v247
    s_waitcnt vmcnt(4)
    ds_read_b64_tr_b16 v[200:201], v12 offset:0
    ds_read_b64_tr_b16 v[202:203], v12 offset:32768
    ds_read_b64_tr_b16 v[204:205], v13 offset:0
    ds_read_b64_tr_b16 v[206:207], v13 offset:32768
    ds_read_b64_tr_b16 v[208:209], v14 offset:0
    ds_read_b64_tr_b16 v[210:211], v14 offset:32768
    ds_read_b64_tr_b16 v[212:213], v15 offset:0
    ds_read_b64_tr_b16 v[214:215], v15 offset:32768
    ds_read_b64_tr_b16 v[216:217], v16 offset:0
    ds_read_b64_tr_b16 v[218:219], v16 offset:32768
    ds_read_b64_tr_b16 v[220:221], v17 offset:0
    ds_read_b64_tr_b16 v[222:223], v17 offset:32768
    ds_read_b64_tr_b16 v[224:225], v18 offset:0
    ds_read_b64_tr_b16 v[226:227], v18 offset:32768
    ds_read_b64_tr_b16 v[228:229], v19 offset:0
    ds_read_b64_tr_b16 v[230:231], v19 offset:32768
    v_mfma_f32_16x16x32_bf16 v[176:179], v[20:23], v[232:235], v[176:179]
    v_mfma_f32_16x16x32_bf16 v[180:183], v[20:23], v[240:243], v[180:183]
    v_max3_f32 v24, v248, v249, v250
    v_max3_f32 v25, v252, v253, v254
    v_max3_f32 v24, v24, v251, v255
    v_max_f32 v24, v24, v25
    v_cmp_lt_f32 vcc, 0x41000000, v24
    s_cbranch_vccnz L_rare2
L_back6_2:
    v_exp_f32 v248, v248
    v_exp_f32 v249, v249
    v_exp_f32 v250, v250
    v_exp_f32 v251, v251
    v_exp_f32 v252, v252
    v_exp_f32 v253, v253
    v_exp_f32 v254, v254
    v_exp_f32 v255, v255
    v_cvt_pk_bf16_f32 v248, v248, v249
    v_cvt_pk_bf16_f32 v249, v250, v251
    v_cvt_pk_bf16_f32 v250, v252, v253
    v_cvt_pk_bf16_f32 v251, v254, v255
    s_waitcnt lgkmcnt(12)
    v_mfma_f32_16x16x32_bf16 v[80:83], v[200:203], v[232:235], v[80:83]
    v_mfma_f32_16x16x32_bf16 v[92:95], v[204:207], v[232:235], v[92:95]
    s_waitcnt lgkmcnt(8)
    v_mfma_f32_16x16x32_bf16 v[104:107], v[208:211], v[232:235], v[104:107]
    v_mfma_f32_16x16x32_bf16 v[116:119], v[212:215], v[232:235], v[116:119]
    s_waitcnt lgkmcnt(4)
    v_mfma_f32_16x16x32_bf16 v[128:131], v[216:219], v[232:235], v[128:131]
    v_mfma_f32_16x16x32_bf16 v[140:143], v[220:223], v[232:235], v[140:143]
    s_waitcnt lgkmcnt(0)
    v_mfma_f32_16x16x32_bf16 v[152:155], v[224:227], v[232:235], v[152:155]
    v_mfma_f32_16x16x32_bf16 v[164:167], v[228:231], v[232:235], v[164:167]
    v_mfma_f32_16x16x32_bf16 v[84:87], v[200:203], v[240:243], v[84:87]
    s_add_u32 m0, s28, 0
    s_add_u32 s30, s25, 57344
    buffer_load_dwordx4 v2, s[52:55], s30 offen offset:0 lds
    v_mfma_f32_16x16x32_bf16 v[96:99], v[204:207], v[240:243], v[96:99]
    buffer_load_dwordx4 v3, s[52:55], s30 offen offset:1024 lds
    v_mfma_f32_16x16x32_bf16 v[108:111], v[208:211], v[240:243], v[108:111]
    buffer_load_dwordx4 v2, s[52:55], s30 offen offset:2048 lds
    v_mfma_f32_16x16x32_bf16 v[120:123], v[212:215], v[240:243], v[120:123]
    buffer_load_dwordx4 v3, s[52:55], s30 offen offset:3072 lds
    v_mfma_f32_16x16x32_bf16 v[132:135], v[216:219], v[240:243], v[132:135]
    s_add_u32 m0, s28, 32768
    s_add_u32 s30, s25, 61440
    buffer_load_dwordx4 v2, s[52:55], s30 offen offset:0 lds
    v_mfma_f32_16x16x32_bf16 v[144:147], v[220:223], v[240:243], v[144:147]
    buffer_load_dwordx4 v3, s[52:55], s30 offen offset:1024 lds
    v_mfma_f32_16x16x32_bf16 v[156:159], v[224:227], v[240:243], v[156:159]
    buffer_load_dwordx4 v2, s[52:55], s30 offen offset:2048 lds
    v_mfma_f32_16x16x32_bf16 v[168:171], v[228:231], v[240:243], v[168:171]
    buffer_load_dwordx4 v3, s[52:55], s30 offen offset:3072 lds
    v_mfma_f32_16x16x32_bf16 v[184:187], v[20:23], v[248:251], v[184:187]
    v_mfma_f32_16x16x32_bf16 v[88:91], v[200:203], v[248:251], v[88:91]
    v_mfma_f32_16x16x32_bf16 v[100:103], v[204:207], v[248:251], v[100:103]
    v_mfma_f32_16x16x32_bf16 v[112:115], v[208:211], v[248:251], v[112:115]
    v_mfma_f32_16x16x32_bf16 v[124:127], v[212:215], v[248:251], v[124:127]
    v_mfma_f32_16x16x32_bf16 v[136:139], v[216:219], v[248:251], v[136:139]
    v_mfma_f32_16x16x32_bf16 v[148:151], v[220:223], v[248:251], v[148:151]
    v_mfma_f32_16x16x32_bf16 v[160:163], v[224:227], v[248:251], v[160:163]
    v_mfma_f32_16x16x32_bf16 v[172:175], v[228:231], v[248:251], v[172:175]
    s_waitcnt vmcnt(8)
    ds_read_b128 v[200:203], v28
    ds_read_b128 v[216:219], v8 offset:0
    ds_read_b128 v[204:207], v29
    ds_read_b128 v[220:223], v9 offset:0
    ds_read_b128 v[208:211], v30
    ds_read_b128 v[224:227], v10 offset:0
    ds_read_b128 v[212:215], v31
    ds_read_b128 v[228:231], v11 offset:0
    s_mov_b32 s36, 7
    s_waitcnt lgkmcnt(6)
    v_mfma_f32_16x16x32_bf16 v[232:235], v[200:203], v[32:35], v[188:191]
    v_mfma_f32_16x16x32_bf16 v[236:239], v[216:219], v[32:35], v[188:191]
    s_waitcnt lgkmcnt(4)
    v_mfma_f32_16x16x32_bf16 v[232:235], v[204:207], v[44:47], v[232:235]
    v_mfma_f32_16x16x32_bf16 v[236:239], v[220:223], v[44:47], v[236:239]
    s_waitcnt lgkmcnt(2)
    v_mfma_f32_16x16x32_bf16 v[232:235], v[208:211], v[56:59], v[232:235]
    v_mfma_f32_16x16x32_bf16 v[236:239], v[224:227], v[56:59], v[236:239]
    s_waitcnt lgkmcnt(0)
    v_mfma_f32_16x16x32_bf16 v[232:235], v[212:215], v[68:71], v[232:235]
    v_mfma_f32_16x16x32_bf16 v[236:239], v[228:231], v[68:71], v[236:239]
    v_mfma_f32_16x16x32_bf16 v[240:243], v[200:203], v[36:39], v[192:195]
    v_lshrrev_b32 v4, 3, v0
    v_lshlrev_b32 v4, 11, v4
    v_and_b32 v5, 7, v0
    v_lshl_add_u32 v4, v5, 4, v4
    s_lshr_b32 s32, s2, 1
    s_and_b32 s33, s2, 1
    s_lshl_b32 s33, s33, 3
    s_add_u32 s33, s33, s3
    s_lshl_b32 s34, s32, 16
    s_lshl_b32 s35, s33, 7
    s_add_u32 s34, s34, s35
    s_add_u32 m0, s28, 98304
    s_add_u32 s30, s34, 0
    buffer_load_dwordx4 v4, s[60:63], s30 offen lds
    v_mfma_f32_16x16x32_bf16 v[244:247], v[216:219], v[36:39], v[192:195]
    v_mfma_f32_16x16x32_bf16 v[240:243], v[204:207], v[48:51], v[240:243]
    s_add_u32 m0, s28, 99328
    s_add_u32 s30, s34, 16384
    buffer_load_dwordx4 v4, s[60:63], s30 offen lds
    v_max3_f32 v24, v232, v233, v234
    v_max3_f32 v25, v236, v237, v238
    v_max3_f32 v24, v24, v235, v239
    v_mfma_f32_16x16x32_bf16 v[244:247], v[220:223], v[48:51], v[244:247]
    v_max_f32 v24, v24, v25
    v_cmp_lt_f32 vcc, 0x41000000, v24
    s_cbranch_vccnz L_rare0
L_back7_0:
    v_mfma_f32_16x16x32_bf16 v[240:243], v[208:211], v[60:63], v[240:243]
    s_add_u32 m0, s28, 100352
    s_add_u32 s30, s34, 32768
    buffer_load_dwordx4 v4, s[60:63], s30 offen lds
    v_exp_f32 v232, v232
    v_exp_f32 v233, v233
    v_exp_f32 v234, v234
    v_mfma_f32_16x16x32_bf16 v[244:247], v[224:227], v[60:63], v[244:247]
    v_exp_f32 v235, v235
    v_exp_f32 v236, v236
    v_exp_f32 v237, v237
    v_mfma_f32_16x16x32_bf16 v[240:243], v[212:215], v[72:75], v[240:243]
    s_add_u32 m0, s28, 101376
    s_add_u32 s30, s34, 49152
    buffer_load_dwordx4 v4, s[60:63], s30 offen lds
    v_exp_f32 v238, v238
    v_exp_f32 v239, v239
    v_cvt_pk_bf16_f32 v232, v232, v233
    v_mfma_f32_16x16x32_bf16 v[244:247], v[228:231], v[72:75], v[244:247]
    v_cvt_pk_bf16_f32 v233, v234, v235
    v_cvt_pk_bf16_f32 v234, v236, v237
    v_cvt_pk_bf16_f32 v235, v238, v239
    v_mfma_f32_16x16x32_bf16 v[248:251], v[200:203], v[40:43], v[196:199]
    v_mfma_f32_16x16x32_bf16 v[252:255], v[216:219], v[40:43], v[196:199]
    v_mfma_f32_16x16x32_bf16 v[248:251], v[204:207], v[52:55], v[248:251]
    v_max3_f32 v24, v240, v241, v242
    v_max3_f32 v25, v244, v245, v246
    v_max3_f32 v24, v24, v243, v247
    v_mfma_f32_16x16x32_bf16 v[252:255], v[220:223], v[52:55], v[252:255]
    v_max_f32 v24, v24, v25
    v_cmp_lt_f32 vcc, 0x41000000, v24
    s_cbranch_vccnz L_rare1
L_back7_1:
    v_mfma_f32_16x16x32_bf16 v[248:251], v[208:211], v[64:67], v[248:251]
    v_exp_f32 v240, v240
    v_exp_f32 v241, v241
    v_exp_f32 v242, v242
    v_mfma_f32_16x16x32_bf16 v[252:255], v[224:227], v[64:67], v[252:255]
    v_exp_f32 v243, v243
    v_exp_f32 v244, v244
    v_exp_f32 v245, v245
    v_mfma_f32_16x16x32_bf16 v[248:251], v[212:215], v[76:79], v[248:251]
    v_exp_f32 v246, v246
    v_exp_f32 v247, v247
    v_cvt_pk_bf16_f32 v240, v240, v241
    v_mfma_f32_16x16x32_bf16 v[252:255], v[228:231], v[76:79], v[252:255]
    v_cvt_pk_bf16_f32 v241, v242, v243
    v_cvt_pk_bf16_f32 v242, v244, v245
    v_cvt_pk_bf16_f32 v243, v246, v247
    s_waitcnt vmcnt(4)
    ds_read_b64_tr_b16 v[200:201], v12 offset:0
    ds_read_b64_tr_b16 v[202:203], v12 offset:32768
    ds_read_b64_tr_b16 v[204:205], v13 offset:0
    ds_read_b64_tr_b16 v[206:207], v13 offset:32768
    ds_read_b64_tr_b16 v[208:209], v14 offset:0
    ds_read_b64_tr_b16 v[210:211], v14 offset:32768
    ds_read_b64_tr_b16 v[212:213], v15 offset:0
    ds_read_b64_tr_b16 v[214:215], v15 offset:32768
    ds_read_b64_tr_b16 v[216:217], v16 offset:0
    ds_read_b64_tr_b16 v[218:219], v16 offset:32768
    ds_read_b64_tr_b16 v[220:221], v17 offset:0
    ds_read_b64_tr_b16 v[222:223], v17 offset:32768
    ds_read_b64_tr_b16 v[224:225], v18 offset:0
    ds_read_b64_tr_b16 v[226:227], v18 offset:32768
    ds_read_b64_tr_b16 v[228:229], v19 offset:0
    ds_read_b64_tr_b16 v[230:231], v19 offset:32768
    v_mfma_f32_16x16x32_bf16 v[176:179], v[20:23], v[232:235], v[176:179]
    v_mfma_f32_16x16x32_bf16 v[180:183], v[20:23], v[240:243], v[180:183]
    v_max3_f32 v24, v248, v249, v250
    v_max3_f32 v25, v252, v253, v254
    v_max3_f32 v24, v24, v251, v255
    v_max_f32 v24, v24, v25
    v_cmp_lt_f32 vcc, 0x41000000, v24
    s_cbranch_vccnz L_rare2
L_back7_2:
    v_exp_f32 v248, v248
    v_exp_f32 v249, v249
    v_exp_f32 v250, v250
    v_exp_f32 v251, v251
    v_exp_f32 v252, v252
    v_exp_f32 v253, v253
    v_exp_f32 v254, v254
    v_exp_f32 v255, v255
    v_cvt_pk_bf16_f32 v248, v248, v249
    v_cvt_pk_bf16_f32 v249, v250, v251
    v_cvt_pk_bf16_f32 v250, v252, v253
    v_cvt_pk_bf16_f32 v251, v254, v255
    v_and_b32 v24, 15, v0
    v_lshlrev_b32 v24, 4, v24
    v_add_u32 v27, 131072, v24
    v_add_u32 v26, s28, v27
    s_waitcnt lgkmcnt(12)
    v_mfma_f32_16x16x32_bf16 v[80:83], v[200:203], v[232:235], v[80:83]
    v_mfma_f32_16x16x32_bf16 v[92:95], v[204:207], v[232:235], v[92:95]
    s_waitcnt lgkmcnt(8)
    v_mfma_f32_16x16x32_bf16 v[104:107], v[208:211], v[232:235], v[104:107]
    v_mfma_f32_16x16x32_bf16 v[116:119], v[212:215], v[232:235], v[116:119]
    s_waitcnt lgkmcnt(4)
    v_mfma_f32_16x16x32_bf16 v[128:131], v[216:219], v[232:235], v[128:131]
    v_mfma_f32_16x16x32_bf16 v[140:143], v[220:223], v[232:235], v[140:143]
    s_waitcnt lgkmcnt(0)
    v_mfma_f32_16x16x32_bf16 v[152:155], v[224:227], v[232:235], v[152:155]
    v_mfma_f32_16x16x32_bf16 v[164:167], v[228:231], v[232:235], v[164:167]
    v_mfma_f32_16x16x32_bf16 v[84:87], v[200:203], v[240:243], v[84:87]
    ds_write_b32 v26, v188 offset:0
    v_mfma_f32_16x16x32_bf16 v[96:99], v[204:207], v[240:243], v[96:99]
    ds_write_b32 v26, v192 offset:4
    v_mfma_f32_16x16x32_bf16 v[108:111], v[208:211], v[240:243], v[108:111]
    ds_write_b32 v26, v196 offset:8
    v_mfma_f32_16x16x32_bf16 v[120:123], v[212:215], v[240:243], v[120:123]
    v_mfma_f32_16x16x32_bf16 v[132:135], v[216:219], v[240:243], v[132:135]
    v_mfma_f32_16x16x32_bf16 v[144:147], v[220:223], v[240:243], v[144:147]
    v_mfma_f32_16x16x32_bf16 v[156:159], v[224:227], v[240:243], v[156:159]
    v_mfma_f32_16x16x32_bf16 v[168:171], v[228:231], v[240:243], v[168:171]
    v_mfma_f32_16x16x32_bf16 v[184:187], v[20:23], v[248:251], v[184:187]
    v_mfma_f32_16x16x32_bf16 v[88:91], v[200:203], v[248:251], v[88:91]
    v_mfma_f32_16x16x32_bf16 v[100:103], v[204:207], v[248:251], v[100:103]
    v_mfma_f32_16x16x32_bf16 v[112:115], v[208:211], v[248:251], v[112:115]
    v_mfma_f32_16x16x32_bf16 v[124:127], v[212:215], v[248:251], v[124:127]
    v_mfma_f32_16x16x32_bf16 v[136:139], v[216:219], v[248:251], v[136:139]
    v_mfma_f32_16x16x32_bf16 v[148:151], v[220:223], v[248:251], v[148:151]
    v_mfma_f32_16x16x32_bf16 v[160:163], v[224:227], v[248:251], v[160:163]
    v_mfma_f32_16x16x32_bf16 v[172:175], v[228:231], v[248:251], v[172:175]
    v_lshrrev_b32 v28, 2, v0
    v_lshlrev_b32 v28, 7, v28
    v_and_b32 v30, 3, v0
    v_lshl_add_u32 v28, v30, 3, v28
    s_add_u32 s29, s28, 98304
    v_add_u32 v28, s29, v28
    s_lshl_b32 s34, s33, 19
    s_lshl_b32 s35, s32, 11
    s_add_u32 s34, s34, s35
    s_add_u32 s34, s34, 4194304
    s_add_u32 s35, s34, 262144
    v_lshlrev_b32 v29, 4, v0
    s_waitcnt vmcnt(0)
    ds_read_b64_tr_b16 v[32:33], v28 offset:0
    ds_read_b64_tr_b16 v[34:35], v28 offset:2048
    ds_read_b64_tr_b16 v[36:37], v28 offset:32
    ds_read_b64_tr_b16 v[38:39], v28 offset:2080
    ds_read_b64_tr_b16 v[40:41], v28 offset:64
    ds_read_b64_tr_b16 v[42:43], v28 offset:2112
    ds_read_b64_tr_b16 v[44:45], v28 offset:96
    ds_read_b64_tr_b16 v[46:47], v28 offset:2144
    s_waitcnt lgkmcnt(0)
    s_barrier
    buffer_store_dwordx4 v[32:35], v29, s[64:67], s34 offen offset:0 sc0 sc1
    buffer_store_dwordx4 v[36:39], v29, s[64:67], s34 offen offset:1024 sc0 sc1
    buffer_store_dwordx4 v[40:43], v29, s[64:67], s35 offen offset:0 sc0 sc1
    buffer_store_dwordx4 v[44:47], v29, s[64:67], s35 offen offset:1024 sc0 sc1
    ds_read_b128 v[200:203], v27 offset:0
    ds_read_b128 v[204:207], v27 offset:4096
    ds_read_b128 v[208:211], v27 offset:8192
    ds_read_b128 v[212:215], v27 offset:12288
    ds_read_b128 v[216:219], v27 offset:16384
    ds_read_b128 v[220:223], v27 offset:20480
    ds_read_b128 v[224:227], v27 offset:24576
    ds_read_b128 v[228:231], v27 offset:28672
    v_lshlrev_b32 v28, 3, v0
    s_lshl_b32 s29, s3, 9
    v_add_u32 v29, s29, v28
    v_add_u32 v30, 49152, v29
    s_mul_i32 s29, s3, 12288
    v_add_u32 v31, s29, v28
    s_waitcnt lgkmcnt(0)
    v_min3_f32 v232, v200, v204, v208
    v_min3_f32 v233, v212, v216, v220
    v_min3_f32 v232, v232, v224, v228
    v_min_f32 v232, v232, v233
    v_sub_f32 v232, v232, v188
    v_exp_f32 v232, v232
    s_nop 0
    v_mov_b32 v233, v232
    v_mul_f32 v176, v176, v232
    ds_write_b32 v26, v176 offset:1024
    v_min3_f32 v234, v201, v205, v209
    v_min3_f32 v235, v213, v217, v221
    v_min3_f32 v234, v234, v225, v229
    v_min_f32 v234, v234, v235
    v_sub_f32 v234, v234, v192
    v_exp_f32 v234, v234
    s_nop 0
    v_mov_b32 v235, v234
    v_mul_f32 v180, v180, v234
    ds_write_b32 v26, v180 offset:1028
    v_min3_f32 v236, v202, v206, v210
    v_min3_f32 v237, v214, v218, v222
    v_min3_f32 v236, v236, v226, v230
    v_min_f32 v236, v236, v237
    v_sub_f32 v236, v236, v196
    v_exp_f32 v236, v236
    s_nop 0
    v_mov_b32 v237, v236
    v_mul_f32 v184, v184, v236
    ds_write_b32 v26, v184 offset:1032
    v_pk_mul_f32 v[80:81], v[80:81], v[232:233]
    v_pk_mul_f32 v[82:83], v[82:83], v[232:233]
    v_cvt_pk_bf16_f32 v80, v80, v81
    v_cvt_pk_bf16_f32 v81, v82, v83
    ds_write_b64 v29, v[80:81] offset:0
    v_pk_mul_f32 v[84:85], v[84:85], v[234:235]
    v_pk_mul_f32 v[86:87], v[86:87], v[234:235]
    v_cvt_pk_bf16_f32 v84, v84, v85
    v_cvt_pk_bf16_f32 v85, v86, v87
    ds_write_b64 v29, v[84:85] offset:4096
    v_pk_mul_f32 v[88:89], v[88:89], v[236:237]
    v_pk_mul_f32 v[90:91], v[90:91], v[236:237]
    v_cvt_pk_bf16_f32 v88, v88, v89
    v_cvt_pk_bf16_f32 v89, v90, v91
    ds_write_b64 v29, v[88:89] offset:8192
    v_pk_mul_f32 v[92:93], v[92:93], v[232:233]
    v_pk_mul_f32 v[94:95], v[94:95], v[232:233]
    v_cvt_pk_bf16_f32 v92, v92, v93
    v_cvt_pk_bf16_f32 v93, v94, v95
    ds_write_b64 v29, v[92:93] offset:12288
    v_pk_mul_f32 v[96:97], v[96:97], v[234:235]
    v_pk_mul_f32 v[98:99], v[98:99], v[234:235]
    v_cvt_pk_bf16_f32 v96, v96, v97
    v_cvt_pk_bf16_f32 v97, v98, v99
    ds_write_b64 v29, v[96:97] offset:16384
    v_pk_mul_f32 v[100:101], v[100:101], v[236:237]
    v_pk_mul_f32 v[102:103], v[102:103], v[236:237]
    v_cvt_pk_bf16_f32 v100, v100, v101
    v_cvt_pk_bf16_f32 v101, v102, v103
    ds_write_b64 v29, v[100:101] offset:20480
    v_pk_mul_f32 v[104:105], v[104:105], v[232:233]
    v_pk_mul_f32 v[106:107], v[106:107], v[232:233]
    v_cvt_pk_bf16_f32 v104, v104, v105
    v_cvt_pk_bf16_f32 v105, v106, v107
    ds_write_b64 v29, v[104:105] offset:24576
    v_pk_mul_f32 v[108:109], v[108:109], v[234:235]
    v_pk_mul_f32 v[110:111], v[110:111], v[234:235]
    v_cvt_pk_bf16_f32 v108, v108, v109
    v_cvt_pk_bf16_f32 v109, v110, v111
    ds_write_b64 v29, v[108:109] offset:28672
    v_pk_mul_f32 v[112:113], v[112:113], v[236:237]
    v_pk_mul_f32 v[114:115], v[114:115], v[236:237]
    v_cvt_pk_bf16_f32 v112, v112, v113
    v_cvt_pk_bf16_f32 v113, v114, v115
    ds_write_b64 v29, v[112:113] offset:32768
    v_pk_mul_f32 v[116:117], v[116:117], v[232:233]
    v_pk_mul_f32 v[118:119], v[118:119], v[232:233]
    v_cvt_pk_bf16_f32 v116, v116, v117
    v_cvt_pk_bf16_f32 v117, v118, v119
    ds_write_b64 v29, v[116:117] offset:36864
    v_pk_mul_f32 v[120:121], v[120:121], v[234:235]
    v_pk_mul_f32 v[122:123], v[122:123], v[234:235]
    v_cvt_pk_bf16_f32 v120, v120, v121
    v_cvt_pk_bf16_f32 v121, v122, v123
    ds_write_b64 v29, v[120:121] offset:40960
    v_pk_mul_f32 v[124:125], v[124:125], v[236:237]
    v_pk_mul_f32 v[126:127], v[126:127], v[236:237]
    v_cvt_pk_bf16_f32 v124, v124, v125
    v_cvt_pk_bf16_f32 v125, v126, v127
    ds_write_b64 v29, v[124:125] offset:45056
    v_pk_mul_f32 v[128:129], v[128:129], v[232:233]
    v_pk_mul_f32 v[130:131], v[130:131], v[232:233]
    v_cvt_pk_bf16_f32 v128, v128, v129
    v_cvt_pk_bf16_f32 v129, v130, v131
    ds_write_b64 v30, v[128:129] offset:0
    v_pk_mul_f32 v[132:133], v[132:133], v[234:235]
    v_pk_mul_f32 v[134:135], v[134:135], v[234:235]
    v_cvt_pk_bf16_f32 v132, v132, v133
    v_cvt_pk_bf16_f32 v133, v134, v135
    ds_write_b64 v30, v[132:133] offset:4096
    v_pk_mul_f32 v[136:137], v[136:137], v[236:237]
    v_pk_mul_f32 v[138:139], v[138:139], v[236:237]
    v_cvt_pk_bf16_f32 v136, v136, v137
    v_cvt_pk_bf16_f32 v137, v138, v139
    ds_write_b64 v30, v[136:137] offset:8192
    v_pk_mul_f32 v[140:141], v[140:141], v[232:233]
    v_pk_mul_f32 v[142:143], v[142:143], v[232:233]
    v_cvt_pk_bf16_f32 v140, v140, v141
    v_cvt_pk_bf16_f32 v141, v142, v143
    ds_write_b64 v30, v[140:141] offset:12288
    v_pk_mul_f32 v[144:145], v[144:145], v[234:235]
    v_pk_mul_f32 v[146:147], v[146:147], v[234:235]
    v_cvt_pk_bf16_f32 v144, v144, v145
    v_cvt_pk_bf16_f32 v145, v146, v147
    ds_write_b64 v30, v[144:145] offset:16384
    v_pk_mul_f32 v[148:149], v[148:149], v[236:237]
    v_pk_mul_f32 v[150:151], v[150:151], v[236:237]
    v_cvt_pk_bf16_f32 v148, v148, v149
    v_cvt_pk_bf16_f32 v149, v150, v151
    ds_write_b64 v30, v[148:149] offset:20480
    v_pk_mul_f32 v[152:153], v[152:153], v[232:233]
    v_pk_mul_f32 v[154:155], v[154:155], v[232:233]
    v_cvt_pk_bf16_f32 v152, v152, v153
    v_cvt_pk_bf16_f32 v153, v154, v155
    ds_write_b64 v30, v[152:153] offset:24576
    v_pk_mul_f32 v[156:157], v[156:157], v[234:235]
    v_pk_mul_f32 v[158:159], v[158:159], v[234:235]
    v_cvt_pk_bf16_f32 v156, v156, v157
    v_cvt_pk_bf16_f32 v157, v158, v159
    ds_write_b64 v30, v[156:157] offset:28672
    v_pk_mul_f32 v[160:161], v[160:161], v[236:237]
    v_pk_mul_f32 v[162:163], v[162:163], v[236:237]
    v_cvt_pk_bf16_f32 v160, v160, v161
    v_cvt_pk_bf16_f32 v161, v162, v163
    ds_write_b64 v30, v[160:161] offset:32768
    v_pk_mul_f32 v[164:165], v[164:165], v[232:233]
    v_pk_mul_f32 v[166:167], v[166:167], v[232:233]
    v_cvt_pk_bf16_f32 v164, v164, v165
    v_cvt_pk_bf16_f32 v165, v166, v167
    ds_write_b64 v30, v[164:165] offset:36864
    v_pk_mul_f32 v[168:169], v[168:169], v[234:235]
    v_pk_mul_f32 v[170:171], v[170:171], v[234:235]
    v_cvt_pk_bf16_f32 v168, v168, v169
    v_cvt_pk_bf16_f32 v169, v170, v171
    ds_write_b64 v30, v[168:169] offset:40960
    v_pk_mul_f32 v[172:173], v[172:173], v[236:237]
    v_pk_mul_f32 v[174:175], v[174:175], v[236:237]
    v_cvt_pk_bf16_f32 v172, v172, v173
    v_cvt_pk_bf16_f32 v173, v174, v175
    ds_write_b64 v30, v[172:173] offset:45056
    v_and_b32 v24, 1, v0
    v_lshlrev_b32 v24, 4, v24
    v_mov_b32 v25, 0x3f80
    v_lshlrev_b32 v24, v24, v25
    v_lshrrev_b32 v25, 4, v0
    v_lshlrev_b32 v25, 1, v25
    v_bfe_u32 v28, v0, 1, 3
    v_cmp_eq_u32 vcc, v25, v28
    v_add_u32 v25, 1, v25
    s_nop 0
    v_cndmask_b32 v20, 0, v24, vcc
    v_cndmask_b32 v22, 0, v24, vcc
    v_cmp_eq_u32 vcc, v25, v28
    s_nop 1
    v_cndmask_b32 v21, 0, v24, vcc
    v_cndmask_b32 v23, 0, v24, vcc
    s_lshl_b32 s29, s18, 5
    s_add_u32 s29, s29, s20
    s_lshl_b32 s29, s29, 2
    s_lshr_b32 s30, s3, 1
    s_add_u32 s29, s29, s30
    s_mul_i32 s29, s29, 3072
    s_and_b32 s30, s3, 1
    s_lshl_b32 s30, s30, 3
    s_add_u32 s29, s29, s30
    v_lshlrev_b32 v29, 4, v0
    s_waitcnt lgkmcnt(0)
    s_barrier
    ds_read_b128 v[200:203], v27 offset:1024
    ds_read_b128 v[204:207], v27 offset:5120
    ds_read_b128 v[208:211], v27 offset:9216
    ds_read_b128 v[212:215], v27 offset:13312
    ds_read_b128 v[216:219], v27 offset:17408
    ds_read_b128 v[220:223], v27 offset:21504
    ds_read_b128 v[224:227], v27 offset:25600
    ds_read_b128 v[228:231], v27 offset:29696
    ds_read2st64_b64 v[80:83], v31 offset0:0 offset1:1
    ds_read2st64_b64 v[84:87], v31 offset0:2 offset1:3
    ds_read2st64_b64 v[88:91], v31 offset0:4 offset1:5
    ds_read2st64_b64 v[92:95], v31 offset0:6 offset1:7
    ds_read2st64_b64 v[96:99], v31 offset0:8 offset1:9
    ds_read2st64_b64 v[100:103], v31 offset0:10 offset1:11
    ds_read2st64_b64 v[104:107], v31 offset0:12 offset1:13
    ds_read2st64_b64 v[108:111], v31 offset0:14 offset1:15
    ds_read2st64_b64 v[112:115], v31 offset0:16 offset1:17
    ds_read2st64_b64 v[116:119], v31 offset0:18 offset1:19
    ds_read2st64_b64 v[120:123], v31 offset0:20 offset1:21
    ds_read2st64_b64 v[124:127], v31 offset0:22 offset1:23
    s_waitcnt lgkmcnt(12)
    v_pk_add_f32 v[200:201], v[200:201], v[216:217]
    v_add_f32 v202, v202, v218
    v_pk_add_f32 v[204:205], v[204:205], v[220:221]
    v_add_f32 v206, v206, v222
    v_pk_add_f32 v[208:209], v[208:209], v[224:225]
    v_add_f32 v210, v210, v226
    v_pk_add_f32 v[212:213], v[212:213], v[228:229]
    v_add_f32 v214, v214, v230
    v_pk_add_f32 v[200:201], v[200:201], v[208:209]
    v_add_f32 v202, v202, v210
    v_pk_add_f32 v[204:205], v[204:205], v[212:213]
    v_add_f32 v206, v206, v214
    v_pk_add_f32 v[200:201], v[200:201], v[204:205]
    v_add_f32 v202, v202, v206
    v_rcp_f32 v200, v200
    v_rcp_f32 v201, v201
    v_rcp_f32 v202, v202
    s_waitcnt lgkmcnt(0)
    v_mfma_f32_16x16x32_bf16 v[232:235], v[20:23], v[80:83], 0
    v_mfma_f32_16x16x32_bf16 v[236:239], v[20:23], v[96:99], 0
    v_mfma_f32_16x16x32_bf16 v[240:243], v[20:23], v[112:115], 0
    v_mfma_f32_16x16x32_bf16 v[232:235], v[20:23], v[84:87], v[232:235]
    v_mfma_f32_16x16x32_bf16 v[236:239], v[20:23], v[100:103], v[236:239]
    v_mfma_f32_16x16x32_bf16 v[240:243], v[20:23], v[116:119], v[240:243]
    v_mfma_f32_16x16x32_bf16 v[232:235], v[20:23], v[88:91], v[232:235]
    v_mfma_f32_16x16x32_bf16 v[236:239], v[20:23], v[104:107], v[236:239]
    v_mfma_f32_16x16x32_bf16 v[240:243], v[20:23], v[120:123], v[240:243]
    v_mfma_f32_16x16x32_bf16 v[232:235], v[20:23], v[92:95], v[232:235]
    v_mfma_f32_16x16x32_bf16 v[236:239], v[20:23], v[108:111], v[236:239]
    v_mfma_f32_16x16x32_bf16 v[240:243], v[20:23], v[124:127], v[240:243]
    s_nop 7
    v_mul_f32 v232, v232, v200
    v_mul_f32 v233, v233, v200
    v_mul_f32 v234, v234, v200
    v_mul_f32 v235, v235, v200
    v_cvt_pk_bf16_f32 v232, v232, v233
    v_cvt_pk_bf16_f32 v233, v234, v235
    buffer_store_dwordx2 v[232:233], v29, s[64:67], s29 offen offset:0 sc0 sc1
    v_mul_f32 v236, v236, v201
    v_mul_f32 v237, v237, v201
    v_mul_f32 v238, v238, v201
    v_mul_f32 v239, v239, v201
    v_cvt_pk_bf16_f32 v236, v236, v237
    v_cvt_pk_bf16_f32 v237, v238, v239
    buffer_store_dwordx2 v[236:237], v29, s[64:67], s29 offen offset:1024 sc0 sc1
    v_mul_f32 v240, v240, v202
    v_mul_f32 v241, v241, v202
    v_mul_f32 v242, v242, v202
    v_mul_f32 v243, v243, v202
    v_cvt_pk_bf16_f32 v240, v240, v241
    v_cvt_pk_bf16_f32 v241, v242, v243
    buffer_store_dwordx2 v[240:241], v29, s[64:67], s29 offen offset:2048 sc0 sc1
L_end0:
    s_endpgm
L_rare0:
    v_max3_f32 v24, v232, v233, v234
    v_max3_f32 v25, v235, v236, v237
    v_max3_f32 v24, v24, v238, v239
    v_max_f32 v24, v24, v25
    v_mov_b32 v25, v24
    s_nop 1
    v_permlane32_swap_b32 v24, v25
    s_nop 1
    v_max_f32 v24, v24, v25
    v_mov_b32 v25, v24
    s_nop 1
    v_permlane16_swap_b32 v24, v25
    s_nop 1
    v_max_f32 v24, v24, v25
    v_max_f32 v24, 0, v24
    v_sub_f32 v25, 0, v24
    v_exp_f32 v25, v25
    v_sub_f32 v188, v188, v24
    v_sub_f32 v189, v189, v24
    v_sub_f32 v190, v190, v24
    v_sub_f32 v191, v191, v24
    v_sub_f32 v232, v232, v24
    v_sub_f32 v233, v233, v24
    v_sub_f32 v234, v234, v24
    v_sub_f32 v235, v235, v24
    v_sub_f32 v236, v236, v24
    v_sub_f32 v237, v237, v24
    v_sub_f32 v238, v238, v24
    v_sub_f32 v239, v239, v24
    v_mul_f32 v176, v176, v25
    v_mul_f32 v177, v177, v25
    v_mul_f32 v178, v178, v25
    v_mul_f32 v179, v179, v25
    v_mul_f32 v80, v80, v25
    v_mul_f32 v81, v81, v25
    v_mul_f32 v82, v82, v25
    v_mul_f32 v83, v83, v25
    v_mul_f32 v92, v92, v25
    v_mul_f32 v93, v93, v25
    v_mul_f32 v94, v94, v25
    v_mul_f32 v95, v95, v25
    v_mul_f32 v104, v104, v25
    v_mul_f32 v105, v105, v25
    v_mul_f32 v106, v106, v25
    v_mul_f32 v107, v107, v25
    v_mul_f32 v116, v116, v25
    v_mul_f32 v117, v117, v25
    v_mul_f32 v118, v118, v25
    v_mul_f32 v119, v119, v25
    v_mul_f32 v128, v128, v25
    v_mul_f32 v129, v129, v25
    v_mul_f32 v130, v130, v25
    v_mul_f32 v131, v131, v25
    v_mul_f32 v140, v140, v25
    v_mul_f32 v141, v141, v25
    v_mul_f32 v142, v142, v25
    v_mul_f32 v143, v143, v25
    v_mul_f32 v152, v152, v25
    v_mul_f32 v153, v153, v25
    v_mul_f32 v154, v154, v25
    v_mul_f32 v155, v155, v25
    v_mul_f32 v164, v164, v25
    v_mul_f32 v165, v165, v25
    v_mul_f32 v166, v166, v25
    v_mul_f32 v167, v167, v25
    s_cmp_eq_u32 s36, 1
    s_cbranch_scc1 L_back1_0
    s_cmp_eq_u32 s36, 2
    s_cbranch_scc1 L_back2_0
    s_cmp_eq_u32 s36, 3
    s_cbranch_scc1 L_back3_0
    s_cmp_eq_u32 s36, 4
    s_cbranch_scc1 L_back4_0
    s_cmp_eq_u32 s36, 5
    s_cbranch_scc1 L_back5_0
    s_cmp_eq_u32 s36, 6
    s_cbranch_scc1 L_back6_0
    s_branch L_back7_0
L_rare1:
    v_max3_f32 v24, v240, v241, v242
    v_max3_f32 v25, v243, v244, v245
    v_max3_f32 v24, v24, v246, v247
    v_max_f32 v24, v24, v25
    v_mov_b32 v25, v24
    s_nop 1
    v_permlane32_swap_b32 v24, v25
    s_nop 1
    v_max_f32 v24, v24, v25
    v_mov_b32 v25, v24
    s_nop 1
    v_permlane16_swap_b32 v24, v25
    s_nop 1
    v_max_f32 v24, v24, v25
    v_max_f32 v24, 0, v24
    v_sub_f32 v25, 0, v24
    v_exp_f32 v25, v25
    v_sub_f32 v192, v192, v24
    v_sub_f32 v193, v193, v24
    v_sub_f32 v194, v194, v24
    v_sub_f32 v195, v195, v24
    v_sub_f32 v240, v240, v24
    v_sub_f32 v241, v241, v24
    v_sub_f32 v242, v242, v24
    v_sub_f32 v243, v243, v24
    v_sub_f32 v244, v244, v24
    v_sub_f32 v245, v245, v24
    v_sub_f32 v246, v246, v24
    v_sub_f32 v247, v247, v24
    v_mul_f32 v180, v180, v25
    v_mul_f32 v181, v181, v25
    v_mul_f32 v182, v182, v25
    v_mul_f32 v183, v183, v25
    v_mul_f32 v84, v84, v25
    v_mul_f32 v85, v85, v25
    v_mul_f32 v86, v86, v25
    v_mul_f32 v87, v87, v25
    v_mul_f32 v96, v96, v25
    v_mul_f32 v97, v97, v25
    v_mul_f32 v98, v98, v25
    v_mul_f32 v99, v99, v25
    v_mul_f32 v108, v108, v25
    v_mul_f32 v109, v109, v25
    v_mul_f32 v110, v110, v25
    v_mul_f32 v111, v111, v25
    v_mul_f32 v120, v120, v25
    v_mul_f32 v121, v121, v25
    v_mul_f32 v122, v122, v25
    v_mul_f32 v123, v123, v25
    v_mul_f32 v132, v132, v25
    v_mul_f32 v133, v133, v25
    v_mul_f32 v134, v134, v25
    v_mul_f32 v135, v135, v25
    v_mul_f32 v144, v144, v25
    v_mul_f32 v145, v145, v25
    v_mul_f32 v146, v146, v25
    v_mul_f32 v147, v147, v25
    v_mul_f32 v156, v156, v25
    v_mul_f32 v157, v157, v25
    v_mul_f32 v158, v158, v25
    v_mul_f32 v159, v159, v25
    v_mul_f32 v168, v168, v25
    v_mul_f32 v169, v169, v25
    v_mul_f32 v170, v170, v25
    v_mul_f32 v171, v171, v25
    s_cmp_eq_u32 s36, 1
    s_cbranch_scc1 L_back1_1
    s_cmp_eq_u32 s36, 2
    s_cbranch_scc1 L_back2_1
    s_cmp_eq_u32 s36, 3
    s_cbranch_scc1 L_back3_1
    s_cmp_eq_u32 s36, 4
    s_cbranch_scc1 L_back4_1
    s_cmp_eq_u32 s36, 5
    s_cbranch_scc1 L_back5_1
    s_cmp_eq_u32 s36, 6
    s_cbranch_scc1 L_back6_1
    s_branch L_back7_1
L_rare2:
    v_max3_f32 v24, v248, v249, v250
    v_max3_f32 v25, v251, v252, v253
    v_max3_f32 v24, v24, v254, v255
    v_max_f32 v24, v24, v25
    v_mov_b32 v25, v24
    s_nop 1
    v_permlane32_swap_b32 v24, v25
    s_nop 1
    v_max_f32 v24, v24, v25
    v_mov_b32 v25, v24
    s_nop 1
    v_permlane16_swap_b32 v24, v25
    s_nop 1
    v_max_f32 v24, v24, v25
    v_max_f32 v24, 0, v24
    v_sub_f32 v25, 0, v24
    v_exp_f32 v25, v25
    v_sub_f32 v196, v196, v24
    v_sub_f32 v197, v197, v24
    v_sub_f32 v198, v198, v24
    v_sub_f32 v199, v199, v24
    v_sub_f32 v248, v248, v24
    v_sub_f32 v249, v249, v24
    v_sub_f32 v250, v250, v24
    v_sub_f32 v251, v251, v24
    v_sub_f32 v252, v252, v24
    v_sub_f32 v253, v253, v24
    v_sub_f32 v254, v254, v24
    v_sub_f32 v255, v255, v24
    v_mul_f32 v184, v184, v25
    v_mul_f32 v185, v185, v25
    v_mul_f32 v186, v186, v25
    v_mul_f32 v187, v187, v25
    v_mul_f32 v88, v88, v25
    v_mul_f32 v89, v89, v25
    v_mul_f32 v90, v90, v25
    v_mul_f32 v91, v91, v25
    v_mul_f32 v100, v100, v25
    v_mul_f32 v101, v101, v25
    v_mul_f32 v102, v102, v25
    v_mul_f32 v103, v103, v25
    v_mul_f32 v112, v112, v25
    v_mul_f32 v113, v113, v25
    v_mul_f32 v114, v114, v25
    v_mul_f32 v115, v115, v25
    v_mul_f32 v124, v124, v25
    v_mul_f32 v125, v125, v25
    v_mul_f32 v126, v126, v25
    v_mul_f32 v127, v127, v25
    v_mul_f32 v136, v136, v25
    v_mul_f32 v137, v137, v25
    v_mul_f32 v138, v138, v25
    v_mul_f32 v139, v139, v25
    v_mul_f32 v148, v148, v25
    v_mul_f32 v149, v149, v25
    v_mul_f32 v150, v150, v25
    v_mul_f32 v151, v151, v25
    v_mul_f32 v160, v160, v25
    v_mul_f32 v161, v161, v25
    v_mul_f32 v162, v162, v25
    v_mul_f32 v163, v163, v25
    v_mul_f32 v172, v172, v25
    v_mul_f32 v173, v173, v25
    v_mul_f32 v174, v174, v25
    v_mul_f32 v175, v175, v25
    s_cmp_eq_u32 s36, 1
    s_cbranch_scc1 L_back1_2
    s_cmp_eq_u32 s36, 2
    s_cbranch_scc1 L_back2_2
    s_cmp_eq_u32 s36, 3
    s_cbranch_scc1 L_back3_2
    s_cmp_eq_u32 s36, 4
    s_cbranch_scc1 L_back4_2
    s_cmp_eq_u32 s36, 5
    s_cbranch_scc1 L_back5_2
    s_cmp_eq_u32 s36, 6
    s_cbranch_scc1 L_back6_2
    s_branch L_back7_2
.globl gqa_oproj_kernel
.p2align 8
.type gqa_oproj_kernel,@function
gqa_oproj_kernel:
    s_cmp_ge_u32 s2, 256
    s_cbranch_scc1 L_end1
    s_load_dwordx2 s[12:13], s[0:1], 40
    s_load_dwordx2 s[14:15], s[0:1], 56
    v_lshrrev_b32 v1, 6, v0
    v_and_b32 v0, 63, v0
    v_readfirstlane_b32 s3, v1
    v_lshlrev_b32 v2, 4, v0
    s_and_b32 s16, s2, 7
    s_lshr_b32 s17, s2, 3
    s_and_b32 s18, s16, 1
    s_lshl_b32 s18, s18, 2
    s_and_b32 s19, s17, 3
    s_add_u32 s18, s18, s19
    s_lshr_b32 s19, s16, 1
    s_lshl_b32 s19, s19, 3
    s_lshr_b32 s20, s17, 2
    s_add_u32 s19, s19, s20
    s_mul_i32 s22, s18, 393216
    s_mul_i32 s23, s3, 49152
    s_add_u32 s22, s22, s23
    s_lshl_b32 s23, s19, 18
    s_lshl_b32 s24, s3, 15
    s_add_u32 s23, s23, s24
    s_add_u32 s23, s23, 4194304
    s_waitcnt lgkmcnt(0)
    s_mov_b32 s44, s14
    s_mov_b32 s45, s15
    s_mov_b32 s46, 12582912
    s_mov_b32 s47, 0x00020000
    s_mov_b32 s48, s12
    s_mov_b32 s49, s13
    s_mov_b32 s50, 786432
    s_mov_b32 s51, 0x00020000
    s_add_u32 s25, s23, 0
    s_add_u32 s26, s22, 0
    buffer_load_dwordx4 v[32:35], v2, s[44:47], s25 offen offset:0
    buffer_load_dwordx4 v[36:39], v2, s[44:47], s25 offen offset:1024
    buffer_load_dwordx4 v[40:43], v2, s[44:47], s26 offen offset:0
    buffer_load_dwordx4 v[44:47], v2, s[44:47], s26 offen offset:1024
    buffer_load_dwordx4 v[48:51], v2, s[44:47], s26 offen offset:2048
    s_add_u32 s25, s23, 2048
    s_add_u32 s26, s22, 3072
    buffer_load_dwordx4 v[52:55], v2, s[44:47], s25 offen offset:0
    buffer_load_dwordx4 v[56:59], v2, s[44:47], s25 offen offset:1024
    buffer_load_dwordx4 v[60:63], v2, s[44:47], s26 offen offset:0
    buffer_load_dwordx4 v[64:67], v2, s[44:47], s26 offen offset:1024
    buffer_load_dwordx4 v[68:71], v2, s[44:47], s26 offen offset:2048
    s_add_u32 s25, s23, 4096
    s_add_u32 s26, s22, 6144
    buffer_load_dwordx4 v[72:75], v2, s[44:47], s25 offen offset:0
    buffer_load_dwordx4 v[76:79], v2, s[44:47], s25 offen offset:1024
    buffer_load_dwordx4 v[80:83], v2, s[44:47], s26 offen offset:0
    buffer_load_dwordx4 v[84:87], v2, s[44:47], s26 offen offset:1024
    buffer_load_dwordx4 v[88:91], v2, s[44:47], s26 offen offset:2048
    s_add_u32 s25, s23, 6144
    s_add_u32 s26, s22, 9216
    buffer_load_dwordx4 v[92:95], v2, s[44:47], s25 offen offset:0
    buffer_load_dwordx4 v[96:99], v2, s[44:47], s25 offen offset:1024
    buffer_load_dwordx4 v[100:103], v2, s[44:47], s26 offen offset:0
    buffer_load_dwordx4 v[104:107], v2, s[44:47], s26 offen offset:1024
    buffer_load_dwordx4 v[108:111], v2, s[44:47], s26 offen offset:2048
    s_add_u32 s25, s23, 8192
    s_add_u32 s26, s22, 12288
    buffer_load_dwordx4 v[112:115], v2, s[44:47], s25 offen offset:0
    buffer_load_dwordx4 v[116:119], v2, s[44:47], s25 offen offset:1024
    buffer_load_dwordx4 v[120:123], v2, s[44:47], s26 offen offset:0
    buffer_load_dwordx4 v[124:127], v2, s[44:47], s26 offen offset:1024
    buffer_load_dwordx4 v[128:131], v2, s[44:47], s26 offen offset:2048
    s_add_u32 s25, s23, 10240
    s_add_u32 s26, s22, 15360
    buffer_load_dwordx4 v[132:135], v2, s[44:47], s25 offen offset:0
    buffer_load_dwordx4 v[136:139], v2, s[44:47], s25 offen offset:1024
    buffer_load_dwordx4 v[140:143], v2, s[44:47], s26 offen offset:0
    buffer_load_dwordx4 v[144:147], v2, s[44:47], s26 offen offset:1024
    buffer_load_dwordx4 v[148:151], v2, s[44:47], s26 offen offset:2048
    s_add_u32 s25, s23, 12288
    s_add_u32 s26, s22, 18432
    buffer_load_dwordx4 v[152:155], v2, s[44:47], s25 offen offset:0
    buffer_load_dwordx4 v[156:159], v2, s[44:47], s25 offen offset:1024
    buffer_load_dwordx4 v[160:163], v2, s[44:47], s26 offen offset:0
    buffer_load_dwordx4 v[164:167], v2, s[44:47], s26 offen offset:1024
    buffer_load_dwordx4 v[168:171], v2, s[44:47], s26 offen offset:2048
    s_add_u32 s25, s23, 14336
    s_add_u32 s26, s22, 21504
    buffer_load_dwordx4 v[172:175], v2, s[44:47], s25 offen offset:0
    buffer_load_dwordx4 v[176:179], v2, s[44:47], s25 offen offset:1024
    buffer_load_dwordx4 v[180:183], v2, s[44:47], s26 offen offset:0
    buffer_load_dwordx4 v[184:187], v2, s[44:47], s26 offen offset:1024
    buffer_load_dwordx4 v[188:191], v2, s[44:47], s26 offen offset:2048
    s_add_u32 s25, s23, 16384
    s_add_u32 s26, s22, 24576
    buffer_load_dwordx4 v[192:195], v2, s[44:47], s25 offen offset:0
    buffer_load_dwordx4 v[196:199], v2, s[44:47], s25 offen offset:1024
    buffer_load_dwordx4 v[200:203], v2, s[44:47], s26 offen offset:0
    buffer_load_dwordx4 v[204:207], v2, s[44:47], s26 offen offset:1024
    buffer_load_dwordx4 v[208:211], v2, s[44:47], s26 offen offset:2048
    s_add_u32 s25, s23, 18432
    s_add_u32 s26, s22, 27648
    buffer_load_dwordx4 v[212:215], v2, s[44:47], s25 offen offset:0
    buffer_load_dwordx4 v[216:219], v2, s[44:47], s25 offen offset:1024
    buffer_load_dwordx4 v[220:223], v2, s[44:47], s26 offen offset:0
    buffer_load_dwordx4 v[224:227], v2, s[44:47], s26 offen offset:1024
    buffer_load_dwordx4 v[228:231], v2, s[44:47], s26 offen offset:2048
    s_add_u32 s25, s23, 20480
    s_add_u32 s26, s22, 30720
    buffer_load_dwordx4 v[232:235], v2, s[44:47], s25 offen offset:0
    buffer_load_dwordx4 v[236:239], v2, s[44:47], s25 offen offset:1024
    buffer_load_dwordx4 v[240:243], v2, s[44:47], s26 offen offset:0
    buffer_load_dwordx4 v[244:247], v2, s[44:47], s26 offen offset:1024
    buffer_load_dwordx4 v[248:251], v2, s[44:47], s26 offen offset:2048
    s_lshl_b32 s27, s3, 10
    v_add_u32 v3, s27, v2
    s_lshl_b32 s27, s3, 13
    v_add_u32 v4, s27, v2
    s_cmp_ge_u32 s3, 3
    s_cselect_b32 s28, 1, 0
    s_mul_i32 s29, s28, 3
    s_sub_u32 s29, s3, s29
    s_mul_i32 s30, s18, 98304
    s_lshl_b32 s29, s29, 15
    s_add_u32 s30, s30, s29
    s_lshl_b32 s29, s19, 6
    s_add_u32 s30, s30, s29
    s_lshl_b32 s29, s28, 5
    s_add_u32 s30, s30, s29
    v_and_b32 v5, 15, v0
    v_lshlrev_b32 v5, 11, v5
    v_lshrrev_b32 v6, 4, v0
    v_lshl_add_u32 v5, v6, 3, v5
    s_waitcnt vmcnt(50)
    v_mfma_f32_16x16x32_bf16 v[8:11], v[32:35], v[40:43], 0
    v_mfma_f32_16x16x32_bf16 v[12:15], v[32:35], v[44:47], 0
    v_mfma_f32_16x16x32_bf16 v[16:19], v[32:35], v[48:51], 0
    v_mfma_f32_16x16x32_bf16 v[20:23], v[36:39], v[40:43], 0
    v_mfma_f32_16x16x32_bf16 v[24:27], v[36:39], v[44:47], 0
    v_mfma_f32_16x16x32_bf16 v[28:31], v[36:39], v[48:51], 0
    s_add_u32 s25, s23, 22528
    s_add_u32 s26, s22, 33792
    buffer_load_dwordx4 v[32:35], v2, s[44:47], s25 offen offset:0
    buffer_load_dwordx4 v[36:39], v2, s[44:47], s25 offen offset:1024
    buffer_load_dwordx4 v[40:43], v2, s[44:47], s26 offen offset:0
    buffer_load_dwordx4 v[44:47], v2, s[44:47], s26 offen offset:1024
    buffer_load_dwordx4 v[48:51], v2, s[44:47], s26 offen offset:2048
    s_waitcnt vmcnt(50)
    v_mfma_f32_16x16x32_bf16 v[8:11], v[52:55], v[60:63], v[8:11]
    v_mfma_f32_16x16x32_bf16 v[12:15], v[52:55], v[64:67], v[12:15]
    v_mfma_f32_16x16x32_bf16 v[16:19], v[52:55], v[68:71], v[16:19]
    v_mfma_f32_16x16x32_bf16 v[20:23], v[56:59], v[60:63], v[20:23]
    v_mfma_f32_16x16x32_bf16 v[24:27], v[56:59], v[64:67], v[24:27]
    v_mfma_f32_16x16x32_bf16 v[28:31], v[56:59], v[68:71], v[28:31]
    s_add_u32 s25, s23, 24576
    s_add_u32 s26, s22, 36864
    buffer_load_dwordx4 v[52:55], v2, s[44:47], s25 offen offset:0
    buffer_load_dwordx4 v[56:59], v2, s[44:47], s25 offen offset:1024
    buffer_load_dwordx4 v[60:63], v2, s[44:47], s26 offen offset:0
    buffer_load_dwordx4 v[64:67], v2, s[44:47], s26 offen offset:1024
    buffer_load_dwordx4 v[68:71], v2, s[44:47], s26 offen offset:2048
    s_waitcnt vmcnt(50)
    v_mfma_f32_16x16x32_bf16 v[8:11], v[72:75], v[80:83], v[8:11]
    v_mfma_f32_16x16x32_bf16 v[12:15], v[72:75], v[84:87], v[12:15]
    v_mfma_f32_16x16x32_bf16 v[16:19], v[72:75], v[88:91], v[16:19]
    v_mfma_f32_16x16x32_bf16 v[20:23], v[76:79], v[80:83], v[20:23]
    v_mfma_f32_16x16x32_bf16 v[24:27], v[76:79], v[84:87], v[24:27]
    v_mfma_f32_16x16x32_bf16 v[28:31], v[76:79], v[88:91], v[28:31]
    s_add_u32 s25, s23, 26624
    s_add_u32 s26, s22, 39936
    buffer_load_dwordx4 v[72:75], v2, s[44:47], s25 offen offset:0
    buffer_load_dwordx4 v[76:79], v2, s[44:47], s25 offen offset:1024
    buffer_load_dwordx4 v[80:83], v2, s[44:47], s26 offen offset:0
    buffer_load_dwordx4 v[84:87], v2, s[44:47], s26 offen offset:1024
    buffer_load_dwordx4 v[88:91], v2, s[44:47], s26 offen offset:2048
    s_waitcnt vmcnt(50)
    v_mfma_f32_16x16x32_bf16 v[8:11], v[92:95], v[100:103], v[8:11]
    v_mfma_f32_16x16x32_bf16 v[12:15], v[92:95], v[104:107], v[12:15]
    v_mfma_f32_16x16x32_bf16 v[16:19], v[92:95], v[108:111], v[16:19]
    v_mfma_f32_16x16x32_bf16 v[20:23], v[96:99], v[100:103], v[20:23]
    v_mfma_f32_16x16x32_bf16 v[24:27], v[96:99], v[104:107], v[24:27]
    v_mfma_f32_16x16x32_bf16 v[28:31], v[96:99], v[108:111], v[28:31]
    s_add_u32 s25, s23, 28672
    s_add_u32 s26, s22, 43008
    buffer_load_dwordx4 v[92:95], v2, s[44:47], s25 offen offset:0
    buffer_load_dwordx4 v[96:99], v2, s[44:47], s25 offen offset:1024
    buffer_load_dwordx4 v[100:103], v2, s[44:47], s26 offen offset:0
    buffer_load_dwordx4 v[104:107], v2, s[44:47], s26 offen offset:1024
    buffer_load_dwordx4 v[108:111], v2, s[44:47], s26 offen offset:2048
    s_waitcnt vmcnt(50)
    v_mfma_f32_16x16x32_bf16 v[8:11], v[112:115], v[120:123], v[8:11]
    v_mfma_f32_16x16x32_bf16 v[12:15], v[112:115], v[124:127], v[12:15]
    v_mfma_f32_16x16x32_bf16 v[16:19], v[112:115], v[128:131], v[16:19]
    v_mfma_f32_16x16x32_bf16 v[20:23], v[116:119], v[120:123], v[20:23]
    v_mfma_f32_16x16x32_bf16 v[24:27], v[116:119], v[124:127], v[24:27]
    v_mfma_f32_16x16x32_bf16 v[28:31], v[116:119], v[128:131], v[28:31]
    s_add_u32 s25, s23, 30720
    s_add_u32 s26, s22, 46080
    buffer_load_dwordx4 v[112:115], v2, s[44:47], s25 offen offset:0
    buffer_load_dwordx4 v[116:119], v2, s[44:47], s25 offen offset:1024
    buffer_load_dwordx4 v[120:123], v2, s[44:47], s26 offen offset:0
    buffer_load_dwordx4 v[124:127], v2, s[44:47], s26 offen offset:1024
    buffer_load_dwordx4 v[128:131], v2, s[44:47], s26 offen offset:2048
    s_waitcnt vmcnt(50)
    v_mfma_f32_16x16x32_bf16 v[8:11], v[132:135], v[140:143], v[8:11]
    v_mfma_f32_16x16x32_bf16 v[12:15], v[132:135], v[144:147], v[12:15]
    v_mfma_f32_16x16x32_bf16 v[16:19], v[132:135], v[148:151], v[16:19]
    v_mfma_f32_16x16x32_bf16 v[20:23], v[136:139], v[140:143], v[20:23]
    v_mfma_f32_16x16x32_bf16 v[24:27], v[136:139], v[144:147], v[24:27]
    v_mfma_f32_16x16x32_bf16 v[28:31], v[136:139], v[148:151], v[28:31]
    s_waitcnt vmcnt(45)
    v_mfma_f32_16x16x32_bf16 v[8:11], v[152:155], v[160:163], v[8:11]
    v_mfma_f32_16x16x32_bf16 v[12:15], v[152:155], v[164:167], v[12:15]
    v_mfma_f32_16x16x32_bf16 v[16:19], v[152:155], v[168:171], v[16:19]
    v_mfma_f32_16x16x32_bf16 v[20:23], v[156:159], v[160:163], v[20:23]
    v_mfma_f32_16x16x32_bf16 v[24:27], v[156:159], v[164:167], v[24:27]
    v_mfma_f32_16x16x32_bf16 v[28:31], v[156:159], v[168:171], v[28:31]
    s_waitcnt vmcnt(40)
    v_mfma_f32_16x16x32_bf16 v[8:11], v[172:175], v[180:183], v[8:11]
    v_mfma_f32_16x16x32_bf16 v[12:15], v[172:175], v[184:187], v[12:15]
    v_mfma_f32_16x16x32_bf16 v[16:19], v[172:175], v[188:191], v[16:19]
    v_mfma_f32_16x16x32_bf16 v[20:23], v[176:179], v[180:183], v[20:23]
    v_mfma_f32_16x16x32_bf16 v[24:27], v[176:179], v[184:187], v[24:27]
    v_mfma_f32_16x16x32_bf16 v[28:31], v[176:179], v[188:191], v[28:31]
    s_waitcnt vmcnt(35)
    v_mfma_f32_16x16x32_bf16 v[8:11], v[192:195], v[200:203], v[8:11]
    v_mfma_f32_16x16x32_bf16 v[12:15], v[192:195], v[204:207], v[12:15]
    v_mfma_f32_16x16x32_bf16 v[16:19], v[192:195], v[208:211], v[16:19]
    v_mfma_f32_16x16x32_bf16 v[20:23], v[196:199], v[200:203], v[20:23]
    v_mfma_f32_16x16x32_bf16 v[24:27], v[196:199], v[204:207], v[24:27]
    v_mfma_f32_16x16x32_bf16 v[28:31], v[196:199], v[208:211], v[28:31]
    s_waitcnt vmcnt(30)
    v_mfma_f32_16x16x32_bf16 v[8:11], v[212:215], v[220:223], v[8:11]
    v_mfma_f32_16x16x32_bf16 v[12:15], v[212:215], v[224:227], v[12:15]
    v_mfma_f32_16x16x32_bf16 v[16:19], v[212:215], v[228:231], v[16:19]
    v_mfma_f32_16x16x32_bf16 v[20:23], v[216:219], v[220:223], v[20:23]
    v_mfma_f32_16x16x32_bf16 v[24:27], v[216:219], v[224:227], v[24:27]
    v_mfma_f32_16x16x32_bf16 v[28:31], v[216:219], v[228:231], v[28:31]
    s_waitcnt vmcnt(25)
    v_mfma_f32_16x16x32_bf16 v[8:11], v[232:235], v[240:243], v[8:11]
    v_mfma_f32_16x16x32_bf16 v[12:15], v[232:235], v[244:247], v[12:15]
    v_mfma_f32_16x16x32_bf16 v[16:19], v[232:235], v[248:251], v[16:19]
    v_mfma_f32_16x16x32_bf16 v[20:23], v[236:239], v[240:243], v[20:23]
    v_mfma_f32_16x16x32_bf16 v[24:27], v[236:239], v[244:247], v[24:27]
    v_mfma_f32_16x16x32_bf16 v[28:31], v[236:239], v[248:251], v[28:31]
    s_waitcnt vmcnt(20)
    v_mfma_f32_16x16x32_bf16 v[8:11], v[32:35], v[40:43], v[8:11]
    v_mfma_f32_16x16x32_bf16 v[12:15], v[32:35], v[44:47], v[12:15]
    v_mfma_f32_16x16x32_bf16 v[16:19], v[32:35], v[48:51], v[16:19]
    v_mfma_f32_16x16x32_bf16 v[20:23], v[36:39], v[40:43], v[20:23]
    v_mfma_f32_16x16x32_bf16 v[24:27], v[36:39], v[44:47], v[24:27]
    v_mfma_f32_16x16x32_bf16 v[28:31], v[36:39], v[48:51], v[28:31]
    s_waitcnt vmcnt(15)
    v_mfma_f32_16x16x32_bf16 v[8:11], v[52:55], v[60:63], v[8:11]
    v_mfma_f32_16x16x32_bf16 v[12:15], v[52:55], v[64:67], v[12:15]
    v_mfma_f32_16x16x32_bf16 v[16:19], v[52:55], v[68:71], v[16:19]
    v_mfma_f32_16x16x32_bf16 v[20:23], v[56:59], v[60:63], v[20:23]
    v_mfma_f32_16x16x32_bf16 v[24:27], v[56:59], v[64:67], v[24:27]
    v_mfma_f32_16x16x32_bf16 v[28:31], v[56:59], v[68:71], v[28:31]
    s_waitcnt vmcnt(10)
    v_mfma_f32_16x16x32_bf16 v[8:11], v[72:75], v[80:83], v[8:11]
    v_mfma_f32_16x16x32_bf16 v[12:15], v[72:75], v[84:87], v[12:15]
    v_mfma_f32_16x16x32_bf16 v[16:19], v[72:75], v[88:91], v[16:19]
    v_mfma_f32_16x16x32_bf16 v[20:23], v[76:79], v[80:83], v[20:23]
    v_mfma_f32_16x16x32_bf16 v[24:27], v[76:79], v[84:87], v[24:27]
    v_mfma_f32_16x16x32_bf16 v[28:31], v[76:79], v[88:91], v[28:31]
    s_waitcnt vmcnt(5)
    v_mfma_f32_16x16x32_bf16 v[8:11], v[92:95], v[100:103], v[8:11]
    v_mfma_f32_16x16x32_bf16 v[12:15], v[92:95], v[104:107], v[12:15]
    v_mfma_f32_16x16x32_bf16 v[16:19], v[92:95], v[108:111], v[16:19]
    v_mfma_f32_16x16x32_bf16 v[20:23], v[96:99], v[100:103], v[20:23]
    v_mfma_f32_16x16x32_bf16 v[24:27], v[96:99], v[104:107], v[24:27]
    v_mfma_f32_16x16x32_bf16 v[28:31], v[96:99], v[108:111], v[28:31]
    s_waitcnt vmcnt(0)
    v_mfma_f32_16x16x32_bf16 v[8:11], v[112:115], v[120:123], v[8:11]
    v_mfma_f32_16x16x32_bf16 v[12:15], v[112:115], v[124:127], v[12:15]
    v_mfma_f32_16x16x32_bf16 v[16:19], v[112:115], v[128:131], v[16:19]
    v_mfma_f32_16x16x32_bf16 v[20:23], v[116:119], v[120:123], v[20:23]
    v_mfma_f32_16x16x32_bf16 v[24:27], v[116:119], v[124:127], v[24:27]
    v_mfma_f32_16x16x32_bf16 v[28:31], v[116:119], v[128:131], v[28:31]
    s_nop 7
    ds_write_b128 v3, v[8:11] offset:0
    ds_write_b128 v3, v[12:15] offset:8192
    ds_write_b128 v3, v[16:19] offset:16384
    ds_write_b128 v3, v[20:23] offset:24576
    ds_write_b128 v3, v[24:27] offset:32768
    ds_write_b128 v3, v[28:31] offset:40960
    s_waitcnt lgkmcnt(0)
    s_barrier
    s_cmp_ge_u32 s3, 6
    s_cbranch_scc1 L_end1
    ds_read_b128 v[32:35], v4 offset:0
    ds_read_b128 v[36:39], v4 offset:1024
    ds_read_b128 v[40:43], v4 offset:2048
    ds_read_b128 v[44:47], v4 offset:3072
    ds_read_b128 v[48:51], v4 offset:4096
    ds_read_b128 v[52:55], v4 offset:5120
    ds_read_b128 v[56:59], v4 offset:6144
    ds_read_b128 v[60:63], v4 offset:7168
    s_waitcnt lgkmcnt(0)
    v_pk_add_f32 v[32:33], v[32:33], v[48:49]
    v_pk_add_f32 v[34:35], v[34:35], v[50:51]
    v_pk_add_f32 v[36:37], v[36:37], v[52:53]
    v_pk_add_f32 v[38:39], v[38:39], v[54:55]
    v_pk_add_f32 v[40:41], v[40:41], v[56:57]
    v_pk_add_f32 v[42:43], v[42:43], v[58:59]
    v_pk_add_f32 v[44:45], v[44:45], v[60:61]
    v_pk_add_f32 v[46:47], v[46:47], v[62:63]
    v_pk_add_f32 v[32:33], v[32:33], v[40:41]
    v_pk_add_f32 v[34:35], v[34:35], v[42:43]
    v_pk_add_f32 v[36:37], v[36:37], v[44:45]
    v_pk_add_f32 v[38:39], v[38:39], v[46:47]
    v_pk_add_f32 v[32:33], v[32:33], v[36:37]
    v_pk_add_f32 v[34:35], v[34:35], v[38:39]
    v_cvt_pk_bf16_f32 v32, v32, v33
    v_cvt_pk_bf16_f32 v33, v34, v35
    buffer_store_dwordx2 v[32:33], v5, s[48:51], s30 offen sc0 sc1
L_end1:
    s_endpgm
.section .rodata,"a"
.p2align 6
.amdhsa_kernel gqa_attn_kernel
  .amdhsa_next_free_vgpr 256
  .amdhsa_next_free_sgpr 102
  .amdhsa_accum_offset 256
  .amdhsa_group_segment_fixed_size 0
  .amdhsa_kernarg_size 64
  .amdhsa_user_sgpr_count 2
  .amdhsa_user_sgpr_kernarg_segment_ptr 1
  .amdhsa_system_sgpr_workgroup_id_x 1
.end_amdhsa_kernel
.p2align 6
.amdhsa_kernel gqa_oproj_kernel
  .amdhsa_next_free_vgpr 256
  .amdhsa_next_free_sgpr 102
  .amdhsa_accum_offset 256
  .amdhsa_group_segment_fixed_size 0
  .amdhsa_kernarg_size 64
  .amdhsa_user_sgpr_count 2
  .amdhsa_user_sgpr_kernarg_segment_ptr 1
  .amdhsa_system_sgpr_workgroup_id_x 1
.end_amdhsa_kernel
```
